```python
import torch

def _softmax(x, axis=-1):
    return torch.softmax(x, dim=axis)

def _gelu(x):
    return torch.nn.functional.gelu(x, approximate='tanh')

def _silu(x):
    return torch.nn.functional.silu(x)

def _sigmoid(x):
    return torch.sigmoid(x)

def _layernorm(x, axis=-1, eps=1e-05):
    m = x.mean(dim=axis, keepdim=True)
    v = x.var(dim=axis, keepdim=True, unbiased=False)
    return (x - m) / torch.sqrt(v + eps)

def _scatter_add(tgt, idx, src, axis=0):
    return tgt.clone().index_add_(axis, idx, src)

def _segment_sum(src, seg, n):
    out = torch.zeros((n,) + src.shape[1:], dtype=src.dtype)
    return out.index_add_(0, seg, src)

def _pad(x, pw):
    flat = tuple((v for pair in reversed(pw) for v in pair))
    return torch.nn.functional.pad(x, flat)
kernel_name = 'recurrent_scan__memory_aug_recurrent_mem_tr__swiglu_ffn__prompt'

def setup_inputs():

    _w = lambda a: (lambda t: t.to(torch.bfloat16) if t.is_floating_point() else t)(torch.as_tensor(a))

    def _A_setup():
        B, S, Dm = (1, 2048, 640)
        H, Dh = (32, 128)
        M, seg = (8, 32)
        seg = min(seg, S)
        S = S // seg * seg
        return {'x': _w((lambda *s: torch.randn(*s, dtype=torch.bfloat16) * 0.05)(B, S, Dm)), 'mem0': _w((lambda *s: torch.randn(*s, dtype=torch.bfloat16) * 0.2)(B, M, Dm)), 'Wq': _w((lambda *s: torch.randn(*s, dtype=torch.bfloat16) * 0.8)(Dm, H, Dh) * Dm ** (-0.5)), 'Wk': _w((lambda *s: torch.randn(*s, dtype=torch.bfloat16) * 0.8)(Dm, H, Dh) * Dm ** (-0.5)), 'Wv': _w((lambda *s: torch.randn(*s, dtype=torch.bfloat16) * 0.2)(Dm, H, Dh) * Dm ** (-0.5)), 'Wo': _w((lambda *s: torch.randn(*s, dtype=torch.bfloat16) * 0.2)(H, Dh, Dm) * (H * Dh) ** (-0.5)), 'seg_len': seg}
    _A_in = _A_setup()

    def _B_setup():
        B, S, D, F = (1, 2048, 640, 1728)
        return {'x': _w((lambda *s: torch.randn(*s, dtype=torch.bfloat16) * 0.05)(B, S, D)), 'w_gate': _w((lambda *s: torch.randn(*s, dtype=torch.bfloat16) * 0.1)(D, F)), 'w_up': _w((lambda *s: torch.randn(*s, dtype=torch.bfloat16) * 0.1)(D, F)), 'w_down': _w((lambda *s: torch.randn(*s, dtype=torch.bfloat16) * 0.1)(F, D))}
    _B_in = _B_setup()
    return {'A_x': _A_in['x'], 'A_mem0': _A_in['mem0'], 'A_Wq': _A_in['Wq'], 'A_Wk': _A_in['Wk'], 'A_Wv': _A_in['Wv'], 'A_Wo': _A_in['Wo'], 'A_seg_len': _A_in['seg_len'], 'B_x': _B_in['x'], 'B_w_gate': _B_in['w_gate'], 'B_w_up': _B_in['w_up'], 'B_w_down': _B_in['w_down']}

def reference(A_x, A_mem0, A_Wq, A_Wk, A_Wv, A_Wo, A_seg_len, B_x, B_w_gate, B_w_up, B_w_down):

    def _A_ref(x, mem0, Wq, Wk, Wv, Wo, seg_len):
        B, S, Dm = x.shape
        H, Dh = (Wq.shape[1], Wq.shape[2])
        M = mem0.shape[1]
        scale = Dh ** (-0.5)
        n_seg = S // seg_len
        L = M + seg_len
        idx = torch.arange(L)
        mask = (idx[:, None] < M) | (idx[:, None] >= idx[None, :])
        mem = mem0
        outs = []
        for s in range(n_seg):
            xs = x[:, s * seg_len:(s + 1) * seg_len, :].clone()
            h = torch.concatenate([mem, xs], axis=1)
            q = torch.einsum('btd,dhe->bhte', h, Wq)
            k = torch.einsum('btd,dhe->bhte', h, Wk)
            v = torch.einsum('btd,dhe->bhte', h, Wv)
            scores = torch.einsum('bhqe,bhke->bhqk', q, k) * scale
            scores = torch.where(mask[None, None], scores, -1000000000.0)
            p = _softmax(scores, axis=-1)
            o = torch.einsum('bhqk,bhke->bhqe', p, v)
            o = torch.einsum('bhte,hed->btd', o, Wo)
            mem = o[:, :M, :].clone()
            outs.append(o[:, M:, :])
        return torch.concatenate(outs, axis=1)

    def _B_ref(x, w_gate, w_up, w_down):
        g = _silu(x @ w_gate)
        u = x @ w_up
        return g * u @ w_down
    x = A_x
    xn = _layernorm(x, axis=-1)
    s = _A_ref(xn, A_mem0, A_Wq, A_Wk, A_Wv, A_Wo, A_seg_len)
    g = _silu(_B_ref(xn, B_w_gate, B_w_up, B_w_down))
    return x + s * g
```

```asm
; @launch grid=(256,1,1) block=(256,1,1) lds=163840
.amdgcn_target "amdgcn-amd-amdhsa--gfx950"
.text
.globl recurrent_scan__memory_aug_recurrent_mem_tr__swiglu_ffn__prompt_kernel
.p2align 8
.type recurrent_scan__memory_aug_recurrent_mem_tr__swiglu_ffn__prompt_kernel,@function
recurrent_scan__memory_aug_recurrent_mem_tr__swiglu_ffn__prompt_kernel:
s_cmp_ge_u32 s2, 256
s_cbranch_scc1 KEND
v_lshrrev_b32 v1, 6, v0
s_nop 0
v_readfirstlane_b32 s24, v1
s_load_dwordx2 s[4:5], s[0:1], 104
s_load_dwordx2 s[16:17], s[0:1], 96
s_load_dwordx2 s[8:9], s[0:1], 8
s_mov_b32 s6, 268435456
s_mov_b32 s7, 0x20000
s_mov_b32 s18, 256
s_mov_b32 s19, 0x20000
s_mov_b32 s10, 10240
s_mov_b32 s11, 0x20000
s_waitcnt lgkmcnt(0)
v_mov_b32 v4, -1
v_mov_b32 v5, -1
v_mov_b32 v6, -1
v_mov_b32 v7, -1
v_mov_b32 v8, 0
v_mov_b32 v9, 0
v_mov_b32 v10, 0
v_mov_b32 v11, 0
v_lshlrev_b32 v2, 4, v0
s_mul_i32 s28, s2, 2560
s_add_u32 s28, s28, 262144
s_mul_i32 s29, s2, 384
s_mul_i32 s30, s2, 160
s_add_u32 s30, s30, 151552
v_cmp_gt_u32 vcc, 160, v0
s_and_saveexec_b64 s[32:33], vcc
buffer_store_dwordx4 v[4:7], v2, s[4:7], s28 offen sc1
s_lshl_b32 s34, s2, 10
s_add_u32 s34, s34, 94109696
s_lshl_b32 s35, s2, 9
s_add_u32 s35, s35, 73269248
s_lshl_b32 s36, s2, 8
s_add_u32 s36, s36, 77529088
v_cmp_gt_u32 vcc, 64, v0
s_and_b64 exec, exec, vcc
buffer_store_dwordx4 v[4:7], v2, s[4:7], s34 offen sc1
v_cmp_gt_u32 vcc, 32, v0
s_and_b64 exec, exec, vcc
buffer_store_dwordx4 v[4:7], v2, s[4:7], s35 offen sc1
v_cmp_gt_u32 vcc, 24, v0
s_and_b64 exec, exec, vcc
buffer_store_dwordx4 v[8:11], v2, s[4:7], s29 offen sc1
v_cmp_gt_u32 vcc, 16, v0
s_and_b64 exec, exec, vcc
buffer_store_dwordx4 v[4:7], v2, s[4:7], s36 offen sc1
v_cmp_gt_u32 vcc, 10, v0
s_and_b64 exec, exec, vcc
buffer_store_dwordx4 v[4:7], v2, s[4:7], s30 offen sc1
s_mov_b64 exec, 1
s_lshl_b32 s31, s2, 3
s_add_u32 s31, s31, 204800
s_cmp_lg_u32 s24, 0
s_cbranch_scc1 PRO_NG
buffer_store_dwordx2 v[8:9], v2, s[4:7], s31 offen sc1
PRO_NG:
s_mov_b64 exec, s[32:33]
s_cmp_ge_u32 s2, 10
s_cbranch_scc1 PRO_NOMEM
s_cmp_lg_u32 s24, 0
s_cbranch_scc1 PRO_NOMEM
v_bfe_u32 v3, v0, 2, 2
v_and_b32 v12, 1, v0
v_lshl_add_u32 v12, v3, 1, v12
v_mul_u32_u24 v12, 1280, v12
v_bfe_u32 v3, v0, 1, 1
v_lshl_add_u32 v12, v3, 4, v12
v_lshrrev_b32 v3, 4, v0
v_lshl_add_u32 v12, v3, 5, v12
s_lshl_b32 s28, s2, 7
buffer_load_dwordx4 v[12:15], v12, s[8:11], s28 offen
s_lshl_b32 s28, s2, 10
s_add_u32 s28, s28, 131072
s_add_u32 s29, s28, 10240
s_waitcnt vmcnt(0)
v_min_u32 v12, -2, v12
v_min_u32 v13, -2, v13
v_min_u32 v14, -2, v14
v_min_u32 v15, -2, v15
buffer_store_dwordx4 v[12:15], v2, s[4:7], s28 offen sc1
buffer_store_dwordx4 v[12:15], v2, s[4:7], s29 offen sc1
PRO_NOMEM:
s_waitcnt vmcnt(0)
s_barrier
s_getreg_b32 s28, hwreg(HW_REG_XCC_ID,0,4)
s_min_u32 s28, s28, 8
s_cmp_lg_u32 s24, 0
s_cbranch_scc1 PRO_W
s_mul_i32 s29, s28, 7
s_lshl_b64 s[30:31], 1, s29
v_mov_b32 v2, s30
v_mov_b32 v3, s31
v_mov_b32 v4, 0
s_mov_b64 exec, 1
buffer_atomic_add_x2 v[2:3], v4, s[16:19], 0 offen sc0
s_mov_b64 exec, -1
s_waitcnt vmcnt(0)
v_readfirstlane_b32 s32, v2
v_readfirstlane_b32 s33, v3
s_lshr_b64 s[34:35], s[32:33], s29
s_and_b32 s36, s34, 127
s_add_u32 s32, s32, s30
s_addc_u32 s33, s33, s31
s_mov_b32 s37, 0
s_lshr_b64 s[34:35], s[32:33], 0
s_and_b32 s34, s34, 127
s_add_u32 s37, s37, s34
s_lshr_b64 s[34:35], s[32:33], 7
s_and_b32 s34, s34, 127
s_add_u32 s37, s37, s34
s_lshr_b64 s[34:35], s[32:33], 14
s_and_b32 s34, s34, 127
s_add_u32 s37, s37, s34
s_lshr_b64 s[34:35], s[32:33], 21
s_and_b32 s34, s34, 127
s_add_u32 s37, s37, s34
s_lshr_b64 s[34:35], s[32:33], 28
s_and_b32 s34, s34, 127
s_add_u32 s37, s37, s34
s_lshr_b64 s[34:35], s[32:33], 35
s_and_b32 s34, s34, 127
s_add_u32 s37, s37, s34
s_lshr_b64 s[34:35], s[32:33], 42
s_and_b32 s34, s34, 127
s_add_u32 s37, s37, s34
s_lshr_b64 s[34:35], s[32:33], 49
s_and_b32 s34, s34, 127
s_add_u32 s37, s37, s34
s_lshr_b64 s[34:35], s[32:33], 56
s_and_b32 s34, s34, 127
s_add_u32 s37, s37, s34
s_cmp_lg_u32 s37, 256
s_cbranch_scc1 PRO_P
s_or_b32 s33, s33, 0x80000000
v_mov_b32 v4, s32
v_mov_b32 v5, s33
v_mov_b32 v6, s32
v_mov_b32 v7, s33
v_lshlrev_b32 v2, 5, v0
s_mov_b32 s29, 204800
buffer_store_dwordx4 v[4:7], v2, s[4:7], s29 offen sc1
buffer_store_dwordx4 v[4:7], v2, s[4:7], s29 offen offset:16 sc1
s_nop 1
v_mov_b32 v4, 0
v_mov_b32 v5, 0
v_mov_b32 v2, 0
s_mov_b64 exec, 1
buffer_store_dwordx2 v[4:5], v2, s[16:19], 0 offen sc1
s_mov_b64 exec, -1
s_branch PRO_D
PRO_P:
s_lshl_b32 s29, s2, 3
s_add_u32 s29, s29, 204800
s_mov_b32 s30, 0
v_mov_b32 v2, 0
PRO_L:
buffer_load_dwordx2 v[4:5], v2, s[4:7], s29 offen sc1
s_waitcnt vmcnt(0)
v_readfirstlane_b32 s32, v4
v_readfirstlane_b32 s33, v5
s_cmp_lt_i32 s33, 0
s_cbranch_scc1 PRO_D
s_add_u32 s30, s30, 1
s_cmp_lt_u32 s30, 131072
s_cbranch_scc1 PRO_L
v_mov_b32 v2, 1
v_mov_b32 v3, 200864
buffer_store_dword v2, v3, s[4:7], 0 offen sc1
s_waitcnt vmcnt(0)
s_endpgm
PRO_D:
v_mov_b32 v4, s32
v_mov_b32 v5, s33
v_mov_b32 v6, s36
v_mov_b32 v3, 0
ds_write_b64 v3, v[4:5]
ds_write_b32 v3, v6 offset:8
s_waitcnt lgkmcnt(0)
PRO_W:
s_barrier
v_mov_b32 v3, 0
ds_read_b64 v[4:5], v3
ds_read_b32 v6, v3 offset:8
s_waitcnt lgkmcnt(0)
v_readfirstlane_b32 s48, v4
v_readfirstlane_b32 s49, v5
v_readfirstlane_b32 s29, v6
s_and_b32 s49, s49, 0x7fffffff
s_lshr_b64 s[30:31], s[48:49], 0
s_and_b32 s32, s30, 127
s_lshr_b64 s[30:31], s[48:49], 7
s_and_b32 s33, s30, 127
s_lshr_b64 s[30:31], s[48:49], 14
s_and_b32 s34, s30, 127
s_lshr_b64 s[30:31], s[48:49], 21
s_and_b32 s35, s30, 127
s_lshr_b64 s[30:31], s[48:49], 28
s_and_b32 s36, s30, 127
s_lshr_b64 s[30:31], s[48:49], 35
s_and_b32 s37, s30, 127
s_lshr_b64 s[30:31], s[48:49], 42
s_and_b32 s38, s30, 127
s_lshr_b64 s[30:31], s[48:49], 49
s_and_b32 s39, s30, 127
s_lshr_b64 s[30:31], s[48:49], 56
s_and_b32 s40, s30, 127
s_mov_b32 s41, 0
s_mov_b32 s42, 0
s_mov_b32 s43, 0
s_mov_b32 s44, 0
s_mov_b32 s45, 0
s_mov_b32 s46, 0
s_mov_b32 s47, 0
s_barrier
s_mov_b32 s30, -1
s_mov_b32 s31, -1
s_cmp_lt_u32 s32, 32
s_cbranch_scc1 R_1
s_cmp_eq_i32 s30, -1
s_cbranch_scc0 R_2
s_mov_b32 s30, 0
s_branch R_1
R_2:
s_cmp_eq_i32 s31, -1
s_cbranch_scc0 R_1
s_mov_b32 s31, 0
R_1:
s_cmp_lt_u32 s33, 32
s_cbranch_scc1 R_3
s_cmp_eq_i32 s30, -1
s_cbranch_scc0 R_4
s_mov_b32 s30, 1
s_branch R_3
R_4:
s_cmp_eq_i32 s31, -1
s_cbranch_scc0 R_3
s_mov_b32 s31, 1
R_3:
s_cmp_lt_u32 s34, 32
s_cbranch_scc1 R_5
s_cmp_eq_i32 s30, -1
s_cbranch_scc0 R_6
s_mov_b32 s30, 2
s_branch R_5
R_6:
s_cmp_eq_i32 s31, -1
s_cbranch_scc0 R_5
s_mov_b32 s31, 2
R_5:
s_cmp_lt_u32 s35, 32
s_cbranch_scc1 R_7
s_cmp_eq_i32 s30, -1
s_cbranch_scc0 R_8
s_mov_b32 s30, 3
s_branch R_7
R_8:
s_cmp_eq_i32 s31, -1
s_cbranch_scc0 R_7
s_mov_b32 s31, 3
R_7:
s_cmp_lt_u32 s36, 32
s_cbranch_scc1 R_9
s_cmp_eq_i32 s30, -1
s_cbranch_scc0 R_10
s_mov_b32 s30, 4
s_branch R_9
R_10:
s_cmp_eq_i32 s31, -1
s_cbranch_scc0 R_9
s_mov_b32 s31, 4
R_9:
s_cmp_lt_u32 s37, 32
s_cbranch_scc1 R_11
s_cmp_eq_i32 s30, -1
s_cbranch_scc0 R_12
s_mov_b32 s30, 5
s_branch R_11
R_12:
s_cmp_eq_i32 s31, -1
s_cbranch_scc0 R_11
s_mov_b32 s31, 5
R_11:
s_cmp_lt_u32 s38, 32
s_cbranch_scc1 R_13
s_cmp_eq_i32 s30, -1
s_cbranch_scc0 R_14
s_mov_b32 s30, 6
s_branch R_13
R_14:
s_cmp_eq_i32 s31, -1
s_cbranch_scc0 R_13
s_mov_b32 s31, 6
R_13:
s_cmp_lt_u32 s39, 32
s_cbranch_scc1 R_15
s_cmp_eq_i32 s30, -1
s_cbranch_scc0 R_16
s_mov_b32 s30, 7
s_branch R_15
R_16:
s_cmp_eq_i32 s31, -1
s_cbranch_scc0 R_15
s_mov_b32 s31, 7
R_15:
s_mov_b32 s27, 1
s_cmp_eq_i32 s31, -1
s_cbranch_scc0 PRO_F
s_mov_b32 s27, 0
s_mov_b32 s30, -2
s_mov_b32 s31, -2
PRO_F:
s_mov_b32 s48, 0
s_cmp_le_u32 s28, 0
s_cbranch_scc1 R_17
s_add_u32 s48, s48, s32
s_cmp_eq_u32 s30, 0
s_cbranch_scc1 R_18
s_cmp_eq_u32 s31, 0
s_cbranch_scc0 R_17
R_18:
s_sub_u32 s48, s48, 32
R_17:
s_cmp_le_u32 s28, 1
s_cbranch_scc1 R_19
s_add_u32 s48, s48, s33
s_cmp_eq_u32 s30, 1
s_cbranch_scc1 R_20
s_cmp_eq_u32 s31, 1
s_cbranch_scc0 R_19
R_20:
s_sub_u32 s48, s48, 32
R_19:
s_cmp_le_u32 s28, 2
s_cbranch_scc1 R_21
s_add_u32 s48, s48, s34
s_cmp_eq_u32 s30, 2
s_cbranch_scc1 R_22
s_cmp_eq_u32 s31, 2
s_cbranch_scc0 R_21
R_22:
s_sub_u32 s48, s48, 32
R_21:
s_cmp_le_u32 s28, 3
s_cbranch_scc1 R_23
s_add_u32 s48, s48, s35
s_cmp_eq_u32 s30, 3
s_cbranch_scc1 R_24
s_cmp_eq_u32 s31, 3
s_cbranch_scc0 R_23
R_24:
s_sub_u32 s48, s48, 32
R_23:
s_cmp_le_u32 s28, 4
s_cbranch_scc1 R_25
s_add_u32 s48, s48, s36
s_cmp_eq_u32 s30, 4
s_cbranch_scc1 R_26
s_cmp_eq_u32 s31, 4
s_cbranch_scc0 R_25
R_26:
s_sub_u32 s48, s48, 32
R_25:
s_cmp_le_u32 s28, 5
s_cbranch_scc1 R_27
s_add_u32 s48, s48, s37
s_cmp_eq_u32 s30, 5
s_cbranch_scc1 R_28
s_cmp_eq_u32 s31, 5
s_cbranch_scc0 R_27
R_28:
s_sub_u32 s48, s48, 32
R_27:
s_cmp_le_u32 s28, 6
s_cbranch_scc1 R_29
s_add_u32 s48, s48, s38
s_cmp_eq_u32 s30, 6
s_cbranch_scc1 R_30
s_cmp_eq_u32 s31, 6
s_cbranch_scc0 R_29
R_30:
s_sub_u32 s48, s48, 32
R_29:
s_cmp_le_u32 s28, 7
s_cbranch_scc1 R_31
s_add_u32 s48, s48, s39
s_cmp_eq_u32 s30, 7
s_cbranch_scc1 R_32
s_cmp_eq_u32 s31, 7
s_cbranch_scc0 R_31
R_32:
s_sub_u32 s48, s48, 32
R_31:
s_cmp_le_u32 s28, 8
s_cbranch_scc1 R_33
s_add_u32 s48, s48, s40
s_cmp_eq_u32 s30, 8
s_cbranch_scc1 R_34
s_cmp_eq_u32 s31, 8
s_cbranch_scc0 R_33
R_34:
s_sub_u32 s48, s48, 32
R_33:
s_add_u32 s48, s48, s29
s_cmp_eq_u32 s27, 0
s_cbranch_scc1 PRO_SLOW
s_mov_b32 s26, 0
s_cmp_eq_u32 s28, s30
s_cbranch_scc1 PRO_CAND
s_mov_b32 s26, 1
s_cmp_eq_u32 s28, s31
s_cbranch_scc1 PRO_CAND
s_mov_b32 s25, s48
s_branch WORKER
PRO_CAND:
s_mov_b32 s25, s29
s_cmp_lt_u32 s29, 32
s_cbranch_scc1 REC
s_sub_u32 s25, s48, 32
s_branch WORKER
PRO_SLOW:
s_lshr_b32 s26, s48, 5
s_and_b32 s25, s48, 31
s_cmp_lt_u32 s48, 64
s_cbranch_scc1 REC
s_sub_u32 s25, s48, 64
s_branch WORKER
WORKER:
v_and_b32 v0, 63, v0
s_load_dwordx2 s[8:9], s[0:1], 0
s_waitcnt lgkmcnt(0)
s_mov_b32 s10, 2621440
s_mov_b32 s11, 0x20000
s_lshl_b32 s28, s25, 2
s_add_u32 s28, s28, s24
s_cmp_ge_u32 s28, 512
s_cbranch_scc1 LNE_35
v_lshrrev_b32 v2, 4, v0
v_mul_u32_u24 v2, 1280, v2
v_and_b32 v3, 15, v0
v_lshl_add_u32 v2, v3, 4, v2
s_mul_i32 s29, s28, 5120
s_add_u32 s30, s29, 1048576
buffer_load_dwordx4 v[4:7], v2, s[8:11], s29 offen offset:0
buffer_load_dwordx4 v[8:11], v2, s[8:11], s29 offen offset:256
buffer_load_dwordx4 v[12:15], v2, s[8:11], s29 offen offset:512
buffer_load_dwordx4 v[16:19], v2, s[8:11], s29 offen offset:768
buffer_load_dwordx4 v[20:23], v2, s[8:11], s29 offen offset:1024
s_waitcnt vmcnt(0)
v_lshlrev_b32 v24, 16, v4
v_and_b32 v25, 0xffff0000, v4
v_lshlrev_b32 v26, 16, v5
v_and_b32 v27, 0xffff0000, v5
v_lshlrev_b32 v28, 16, v6
v_and_b32 v29, 0xffff0000, v6
v_lshlrev_b32 v30, 16, v7
v_and_b32 v31, 0xffff0000, v7
v_lshlrev_b32 v32, 16, v8
v_and_b32 v33, 0xffff0000, v8
v_lshlrev_b32 v34, 16, v9
v_and_b32 v35, 0xffff0000, v9
v_lshlrev_b32 v36, 16, v10
v_and_b32 v37, 0xffff0000, v10
v_lshlrev_b32 v38, 16, v11
v_and_b32 v39, 0xffff0000, v11
v_lshlrev_b32 v40, 16, v12
v_and_b32 v41, 0xffff0000, v12
v_lshlrev_b32 v42, 16, v13
v_and_b32 v43, 0xffff0000, v13
v_lshlrev_b32 v44, 16, v14
v_and_b32 v45, 0xffff0000, v14
v_lshlrev_b32 v46, 16, v15
v_and_b32 v47, 0xffff0000, v15
v_lshlrev_b32 v48, 16, v16
v_and_b32 v49, 0xffff0000, v16
v_lshlrev_b32 v50, 16, v17
v_and_b32 v51, 0xffff0000, v17
v_lshlrev_b32 v52, 16, v18
v_and_b32 v53, 0xffff0000, v18
v_lshlrev_b32 v54, 16, v19
v_and_b32 v55, 0xffff0000, v19
v_lshlrev_b32 v56, 16, v20
v_and_b32 v57, 0xffff0000, v20
v_lshlrev_b32 v58, 16, v21
v_and_b32 v59, 0xffff0000, v21
v_lshlrev_b32 v60, 16, v22
v_and_b32 v61, 0xffff0000, v22
v_lshlrev_b32 v62, 16, v23
v_and_b32 v63, 0xffff0000, v23
v_add_f32 v3, v24, v25
v_add_f32 v3, v3, v26
v_add_f32 v3, v3, v27
v_add_f32 v3, v3, v28
v_add_f32 v3, v3, v29
v_add_f32 v3, v3, v30
v_add_f32 v3, v3, v31
v_add_f32 v3, v3, v32
v_add_f32 v3, v3, v33
v_add_f32 v3, v3, v34
v_add_f32 v3, v3, v35
v_add_f32 v3, v3, v36
v_add_f32 v3, v3, v37
v_add_f32 v3, v3, v38
v_add_f32 v3, v3, v39
v_add_f32 v3, v3, v40
v_add_f32 v3, v3, v41
v_add_f32 v3, v3, v42
v_add_f32 v3, v3, v43
v_add_f32 v3, v3, v44
v_add_f32 v3, v3, v45
v_add_f32 v3, v3, v46
v_add_f32 v3, v3, v47
v_add_f32 v3, v3, v48
v_add_f32 v3, v3, v49
v_add_f32 v3, v3, v50
v_add_f32 v3, v3, v51
v_add_f32 v3, v3, v52
v_add_f32 v3, v3, v53
v_add_f32 v3, v3, v54
v_add_f32 v3, v3, v55
v_add_f32 v3, v3, v56
v_add_f32 v3, v3, v57
v_add_f32 v3, v3, v58
v_add_f32 v3, v3, v59
v_add_f32 v3, v3, v60
v_add_f32 v3, v3, v61
v_add_f32 v3, v3, v62
v_add_f32 v3, v3, v63
s_nop 1
v_add_f32_dpp v3, v3, v3 row_ror:8 row_mask:0xf bank_mask:0xf
s_nop 1
v_add_f32_dpp v3, v3, v3 row_ror:4 row_mask:0xf bank_mask:0xf
s_nop 1
v_add_f32_dpp v3, v3, v3 row_ror:2 row_mask:0xf bank_mask:0xf
s_nop 1
v_add_f32_dpp v3, v3, v3 row_ror:1 row_mask:0xf bank_mask:0xf
v_mul_f32 v3, 0x3acccccd, v3
v_sub_f32 v24, v24, v3
v_sub_f32 v25, v25, v3
v_sub_f32 v26, v26, v3
v_sub_f32 v27, v27, v3
v_sub_f32 v28, v28, v3
v_sub_f32 v29, v29, v3
v_sub_f32 v30, v30, v3
v_sub_f32 v31, v31, v3
v_sub_f32 v32, v32, v3
v_sub_f32 v33, v33, v3
v_sub_f32 v34, v34, v3
v_sub_f32 v35, v35, v3
v_sub_f32 v36, v36, v3
v_sub_f32 v37, v37, v3
v_sub_f32 v38, v38, v3
v_sub_f32 v39, v39, v3
v_sub_f32 v40, v40, v3
v_sub_f32 v41, v41, v3
v_sub_f32 v42, v42, v3
v_sub_f32 v43, v43, v3
v_sub_f32 v44, v44, v3
v_sub_f32 v45, v45, v3
v_sub_f32 v46, v46, v3
v_sub_f32 v47, v47, v3
v_sub_f32 v48, v48, v3
v_sub_f32 v49, v49, v3
v_sub_f32 v50, v50, v3
v_sub_f32 v51, v51, v3
v_sub_f32 v52, v52, v3
v_sub_f32 v53, v53, v3
v_sub_f32 v54, v54, v3
v_sub_f32 v55, v55, v3
v_sub_f32 v56, v56, v3
v_sub_f32 v57, v57, v3
v_sub_f32 v58, v58, v3
v_sub_f32 v59, v59, v3
v_sub_f32 v60, v60, v3
v_sub_f32 v61, v61, v3
v_sub_f32 v62, v62, v3
v_sub_f32 v63, v63, v3
v_mul_f32 v3, v24, v24
v_fmac_f32 v3, v25, v25
v_fmac_f32 v3, v26, v26
v_fmac_f32 v3, v27, v27
v_fmac_f32 v3, v28, v28
v_fmac_f32 v3, v29, v29
v_fmac_f32 v3, v30, v30
v_fmac_f32 v3, v31, v31
v_fmac_f32 v3, v32, v32
v_fmac_f32 v3, v33, v33
v_fmac_f32 v3, v34, v34
v_fmac_f32 v3, v35, v35
v_fmac_f32 v3, v36, v36
v_fmac_f32 v3, v37, v37
v_fmac_f32 v3, v38, v38
v_fmac_f32 v3, v39, v39
v_fmac_f32 v3, v40, v40
v_fmac_f32 v3, v41, v41
v_fmac_f32 v3, v42, v42
v_fmac_f32 v3, v43, v43
v_fmac_f32 v3, v44, v44
v_fmac_f32 v3, v45, v45
v_fmac_f32 v3, v46, v46
v_fmac_f32 v3, v47, v47
v_fmac_f32 v3, v48, v48
v_fmac_f32 v3, v49, v49
v_fmac_f32 v3, v50, v50
v_fmac_f32 v3, v51, v51
v_fmac_f32 v3, v52, v52
v_fmac_f32 v3, v53, v53
v_fmac_f32 v3, v54, v54
v_fmac_f32 v3, v55, v55
v_fmac_f32 v3, v56, v56
v_fmac_f32 v3, v57, v57
v_fmac_f32 v3, v58, v58
v_fmac_f32 v3, v59, v59
v_fmac_f32 v3, v60, v60
v_fmac_f32 v3, v61, v61
v_fmac_f32 v3, v62, v62
v_fmac_f32 v3, v63, v63
s_nop 1
v_add_f32_dpp v3, v3, v3 row_ror:8 row_mask:0xf bank_mask:0xf
s_nop 1
v_add_f32_dpp v3, v3, v3 row_ror:4 row_mask:0xf bank_mask:0xf
s_nop 1
v_add_f32_dpp v3, v3, v3 row_ror:2 row_mask:0xf bank_mask:0xf
s_nop 1
v_add_f32_dpp v3, v3, v3 row_ror:1 row_mask:0xf bank_mask:0xf
v_mov_b32 v64, 0x3727c5ac
v_mov_b32 v65, 0x3acccccd
v_fma_f32 v3, v3, v65, v64
v_rsq_f32 v3, v3
s_nop 0
v_mul_f32 v24, v24, v3
v_mul_f32 v25, v25, v3
v_mul_f32 v26, v26, v3
v_mul_f32 v27, v27, v3
v_mul_f32 v28, v28, v3
v_mul_f32 v29, v29, v3
v_mul_f32 v30, v30, v3
v_mul_f32 v31, v31, v3
v_mul_f32 v32, v32, v3
v_mul_f32 v33, v33, v3
v_mul_f32 v34, v34, v3
v_mul_f32 v35, v35, v3
v_mul_f32 v36, v36, v3
v_mul_f32 v37, v37, v3
v_mul_f32 v38, v38, v3
v_mul_f32 v39, v39, v3
v_mul_f32 v40, v40, v3
v_mul_f32 v41, v41, v3
v_mul_f32 v42, v42, v3
v_mul_f32 v43, v43, v3
v_mul_f32 v44, v44, v3
v_mul_f32 v45, v45, v3
v_mul_f32 v46, v46, v3
v_mul_f32 v47, v47, v3
v_mul_f32 v48, v48, v3
v_mul_f32 v49, v49, v3
v_mul_f32 v50, v50, v3
v_mul_f32 v51, v51, v3
v_mul_f32 v52, v52, v3
v_mul_f32 v53, v53, v3
v_mul_f32 v54, v54, v3
v_mul_f32 v55, v55, v3
v_mul_f32 v56, v56, v3
v_mul_f32 v57, v57, v3
v_mul_f32 v58, v58, v3
v_mul_f32 v59, v59, v3
v_mul_f32 v60, v60, v3
v_mul_f32 v61, v61, v3
v_mul_f32 v62, v62, v3
v_mul_f32 v63, v63, v3
v_cvt_pk_bf16_f32 v4, v24, v25
v_cvt_pk_bf16_f32 v5, v26, v27
v_cvt_pk_bf16_f32 v6, v28, v29
v_cvt_pk_bf16_f32 v7, v30, v31
v_cvt_pk_bf16_f32 v8, v32, v33
v_cvt_pk_bf16_f32 v9, v34, v35
v_cvt_pk_bf16_f32 v10, v36, v37
v_cvt_pk_bf16_f32 v11, v38, v39
v_cvt_pk_bf16_f32 v12, v40, v41
v_cvt_pk_bf16_f32 v13, v42, v43
v_cvt_pk_bf16_f32 v14, v44, v45
v_cvt_pk_bf16_f32 v15, v46, v47
v_cvt_pk_bf16_f32 v16, v48, v49
v_cvt_pk_bf16_f32 v17, v50, v51
v_cvt_pk_bf16_f32 v18, v52, v53
v_cvt_pk_bf16_f32 v19, v54, v55
v_cvt_pk_bf16_f32 v20, v56, v57
v_cvt_pk_bf16_f32 v21, v58, v59
v_cvt_pk_bf16_f32 v22, v60, v61
v_cvt_pk_bf16_f32 v23, v62, v63
buffer_store_dwordx4 v[4:7], v2, s[4:7], s30 offen offset:0 sc1
buffer_store_dwordx4 v[8:11], v2, s[4:7], s30 offen offset:256 sc1
buffer_store_dwordx4 v[12:15], v2, s[4:7], s30 offen offset:512 sc1
buffer_store_dwordx4 v[16:19], v2, s[4:7], s30 offen offset:768 sc1
buffer_store_dwordx4 v[20:23], v2, s[4:7], s30 offen offset:1024 sc1
LNE_35:
s_lshl_b32 s31, s25, 2
s_waitcnt vmcnt(0)
s_barrier
s_cmp_lg_u32 s24, 0
s_cbranch_scc1 SG_36
v_mov_b32 v3, 0
v_mov_b32 v2, 1
s_mov_b64 exec, 1
buffer_store_dword v2, v3, s[4:7], s31 offen sc1
s_mov_b64 exec, -1
SG_36:
s_cmp_lg_u32 s24, 0
s_cbranch_scc1 LW_37
v_mbcnt_lo_u32_b32 v3, -1, 0
v_mbcnt_hi_u32_b32 v3, -1, v3
v_min_u32 v3, 47, v3
v_lshlrev_b32 v3, 4, v3
s_mov_b32 s28, 0
PL_38:
buffer_load_dwordx4 v[4:7], v3, s[4:7], 0 offen sc1
s_waitcnt vmcnt(0)
v_min_u32 v2, v4, v5
v_min3_u32 v2, v2, v6, v7
v_cmp_eq_u32 vcc, 0, v2
s_cbranch_vccz PD_39
s_add_u32 s28, s28, 1
s_cmp_lt_u32 s28, 131072
s_cbranch_scc1 PL_38
v_mov_b32 v2, 2
v_mov_b32 v3, 200864
buffer_store_dword v2, v3, s[4:7], 0 offen sc1
s_waitcnt vmcnt(0)
s_endpgm
PD_39:
LW_37:
s_barrier
s_mul_i32 s62, s25, 21846
s_lshr_b32 s62, s62, 16
s_mul_i32 s28, s62, 3
s_sub_u32 s63, s25, s28
s_mov_b32 s61, 0
s_lshr_b32 s28, s24, 1
s_and_b32 s29, s24, 1
v_and_b32 v2, 31, v0
v_lshrrev_b32 v3, 5, v0
v_bfe_u32 v4, v0, 1, 3
s_lshl_b32 s30, s28, 13
v_lshl_add_u32 v5, v2, 7, s30
v_add_u32 v6, 0, v3
v_xor_b32 v6, v6, v4
v_lshl_add_u32 v168, v6, 4, v5
v_add_u32 v6, 2, v3
v_xor_b32 v6, v6, v4
v_lshl_add_u32 v169, v6, 4, v5
v_add_u32 v6, 4, v3
v_xor_b32 v6, v6, v4
v_lshl_add_u32 v170, v6, 4, v5
v_add_u32 v6, 6, v3
v_xor_b32 v6, v6, v4
v_lshl_add_u32 v171, v6, 4, v5
v_lshrrev_b32 v2, 5, v0
v_bfe_u32 v3, v0, 2, 2
v_lshl_add_u32 v2, v2, 3, v3
v_lshlrev_b32 v2, 7, v2
v_bfe_u32 v3, v0, 3, 1
v_xor_b32 v3, s29, v3
v_lshl_add_u32 v2, v3, 6, v2
v_bfe_u32 v3, v0, 4, 1
v_lshl_add_u32 v2, v3, 5, v2
v_and_b32 v3, 3, v0
v_lshl_add_u32 v2, v3, 3, v2
v_add_u32 v172, 16384, v2
WTASK:
s_mul_i32 s28, s61, 192
s_add_u32 s28, s28, s25
s_cmp_ge_u32 s28, 2048
s_cbranch_scc1 WBATCH_END
s_cmp_ge_u32 s28, 960
s_cbranch_scc1 WD1
s_mul_i32 s56, s61, 3
s_add_u32 s56, s56, s63
s_mov_b32 s57, s62
s_branch WD_KV
WD1:
s_sub_u32 s28, s28, 960
s_cmp_ge_u32 s28, 64
s_cbranch_scc1 WD2
s_mov_b32 s56, 15
s_mov_b32 s57, s28
WD_KV:
s_mov_b32 s55, 0
s_cmp_lt_u32 s57, 32
s_cbranch_scc1 WD_K
s_sub_u32 s57, s57, 32
s_mov_b32 s55, 1
s_load_dwordx2 s[12:13], s[0:1], 32
s_waitcnt lgkmcnt(0)
s_mov_b32 s14, 5242880
s_mov_b32 s15, 0x20000
s_mov_b32 s68, 20971520
s_branch WD_QKV
WD_K:
s_load_dwordx2 s[12:13], s[0:1], 24
s_waitcnt lgkmcnt(0)
s_mov_b32 s14, 5242880
s_mov_b32 s15, 0x20000
s_mov_b32 s68, 4194304
s_branch WD_QKV
WD2:
s_sub_u32 s28, s28, 64
s_cmp_ge_u32 s28, 432
s_cbranch_scc1 WD3
s_mul_i32 s29, s28, 607
s_lshr_b32 s29, s29, 16
s_mul_i32 s30, s29, 108
s_sub_u32 s30, s28, s30
s_and_b32 s31, s30, 3
s_lshl_b32 s29, s29, 2
s_add_u32 s56, s29, s31
s_lshr_b32 s57, s30, 2
s_mov_b32 s55, 3
s_cmp_lt_u32 s24, 2
s_cbranch_scc1 WD_G
s_load_dwordx2 s[12:13], s[0:1], 72
s_waitcnt lgkmcnt(0)
s_mov_b32 s14, 2211840
s_mov_b32 s15, 0x20000
s_branch WD_G2
WD_G:
s_load_dwordx2 s[12:13], s[0:1], 64
s_waitcnt lgkmcnt(0)
s_mov_b32 s14, 2211840
s_mov_b32 s15, 0x20000
WD_G2:
s_mov_b32 s52, 1280
s_mov_b32 s53, 3456
s_mov_b32 s54, 10
s_lshl_b32 s51, s57, 7
s_mul_i32 s50, s56, 163840
s_add_u32 s50, s50, 1048576
s_branch WD_DONE
WD3:
s_sub_u32 s28, s28, 432
s_cmp_ge_u32 s28, 512
s_cbranch_scc1 WD4
s_lshr_b32 s29, s28, 7
s_lshl_b32 s29, s29, 2
s_and_b32 s30, s28, 3
s_add_u32 s56, s29, s30
s_bfe_u32 s57, s28, 0x50002
s_mov_b32 s55, 2
s_load_dwordx2 s[12:13], s[0:1], 16
s_waitcnt lgkmcnt(0)
s_mov_b32 s14, 5242880
s_mov_b32 s15, 0x20000
s_mov_b32 s68, 37748736
WD_QKV:
s_mov_b32 s52, 1280
s_mov_b32 s53, 8192
s_mov_b32 s54, 10
s_lshl_b32 s51, s57, 8
s_lshr_b32 s29, s24, 1
s_lshl_b32 s29, s29, 7
s_add_u32 s51, s51, s29
s_mul_i32 s50, s56, 163840
s_add_u32 s50, s50, 1048576
s_branch WD_DONE
WD4:
s_sub_u32 s28, s28, 512
s_mul_i32 s56, s28, 13108
s_lshr_b32 s56, s56, 16
s_mul_i32 s29, s56, 5
s_sub_u32 s57, s28, s29
s_mov_b32 s55, 4
s_load_dwordx2 s[12:13], s[0:1], 80
s_waitcnt lgkmcnt(0)
s_mov_b32 s14, 2211840
s_mov_b32 s15, 0x20000
s_mov_b32 s52, 3456
s_mov_b32 s53, 1280
s_mov_b32 s54, 27
s_lshl_b32 s51, s57, 8
s_lshr_b32 s29, s24, 1
s_lshl_b32 s29, s29, 7
s_add_u32 s51, s51, s29
s_mul_i32 s50, s56, 442368
s_add_u32 s50, s50, 54525952
s_lshl_b32 s30, s56, 7
s_add_u32 s30, s30, 7168
v_mbcnt_lo_u32_b32 v3, -1, 0
v_mbcnt_hi_u32_b32 v3, -1, v3
v_min_u32 v3, 26, v3
v_lshlrev_b32 v3, 2, v3
s_mov_b32 s28, 0
PL_40:
buffer_load_dword v2, v3, s[4:7], s30 offen sc1
s_waitcnt vmcnt(0)
v_cmp_eq_u32 vcc, 0, v2
s_cbranch_vccz PD_41
s_add_u32 s28, s28, 1
s_cmp_lt_u32 s28, 131072
s_cbranch_scc1 PL_40
v_mov_b32 v2, 3
v_mov_b32 v3, 200864
buffer_store_dword v2, v3, s[4:7], 0 offen sc1
s_waitcnt vmcnt(0)
s_endpgm
PD_41:
WD_DONE:
v_lshrrev_b32 v2, 3, v0
s_lshl_b32 s28, s24, 5
v_add_u32 v3, s28, v2
v_and_b32 v4, 7, v0
v_lshrrev_b32 v5, 4, v0
v_add_u32 v6, 0, v3
v_mul_lo_u32 v6, v6, s52
v_add_u32 v7, 0, v5
v_xor_b32 v7, v7, v4
v_lshl_add_u32 v6, v7, 4, v6
v_subrev_u32 v160, 0, v6
v_add_u32 v6, 8, v3
v_mul_lo_u32 v6, v6, s52
v_add_u32 v7, 4, v5
v_xor_b32 v7, v7, v4
v_lshl_add_u32 v6, v7, 4, v6
v_subrev_u32 v161, 1024, v6
v_add_u32 v6, 16, v3
v_mul_lo_u32 v6, v6, s52
v_add_u32 v7, 0, v5
v_xor_b32 v7, v7, v4
v_lshl_add_u32 v6, v7, 4, v6
v_subrev_u32 v162, 2048, v6
v_add_u32 v6, 24, v3
v_mul_lo_u32 v6, v6, s52
v_add_u32 v7, 4, v5
v_xor_b32 v7, v7, v4
v_lshl_add_u32 v6, v7, 4, v6
v_subrev_u32 v163, 3072, v6
s_and_b32 s28, s24, 1
s_lshl_b32 s28, s28, 5
v_add_u32 v3, s28, v2
v_and_b32 v5, 1, v5
v_lshlrev_b32 v5, 2, v5
v_xor_b32 v7, v5, v4
v_add_u32 v6, 0, v3
v_mul_lo_u32 v6, v6, s53
v_lshl_add_u32 v6, v7, 4, v6
v_subrev_u32 v164, 0, v6
v_add_u32 v6, 8, v3
v_mul_lo_u32 v6, v6, s53
v_lshl_add_u32 v6, v7, 4, v6
v_subrev_u32 v165, 1024, v6
v_add_u32 v6, 16, v3
v_mul_lo_u32 v6, v6, s53
v_lshl_add_u32 v6, v7, 4, v6
v_subrev_u32 v166, 2048, v6
v_add_u32 v6, 24, v3
v_mul_lo_u32 v6, v6, s53
v_lshl_add_u32 v6, v7, 4, v6
v_subrev_u32 v167, 3072, v6
s_mov_b32 s66, s50
s_mov_b32 s67, s51
s_mov_b32 s59, 0
s_mov_b32 s58, 0
s_and_b32 s64, s59, 3
s_lshl_b32 s64, s64, 15
s_lshl_b32 s65, s24, 12
s_add_u32 s64, s64, s65
s_mov_b32 m0, s64
s_nop 0
buffer_load_dwordx4 v160, s[4:7], s66 offen offset:0 sc1 lds
buffer_load_dwordx4 v161, s[4:7], s66 offen offset:1024 sc1 lds
buffer_load_dwordx4 v162, s[4:7], s66 offen offset:2048 sc1 lds
buffer_load_dwordx4 v163, s[4:7], s66 offen offset:3072 sc1 lds
s_add_u32 m0, s64, 16384
s_nop 0
buffer_load_dwordx4 v164, s[12:15], s67 offen offset:0 lds
buffer_load_dwordx4 v165, s[12:15], s67 offen offset:1024 lds
buffer_load_dwordx4 v166, s[12:15], s67 offen offset:2048 lds
buffer_load_dwordx4 v167, s[12:15], s67 offen offset:3072 lds
s_add_u32 s66, s66, 128
s_lshl_b32 s65, s53, 6
s_add_u32 s67, s67, s65
s_add_u32 s59, s59, 1
s_and_b32 s64, s59, 3
s_lshl_b32 s64, s64, 15
s_lshl_b32 s65, s24, 12
s_add_u32 s64, s64, s65
s_mov_b32 m0, s64
s_nop 0
buffer_load_dwordx4 v160, s[4:7], s66 offen offset:0 sc1 lds
buffer_load_dwordx4 v161, s[4:7], s66 offen offset:1024 sc1 lds
buffer_load_dwordx4 v162, s[4:7], s66 offen offset:2048 sc1 lds
buffer_load_dwordx4 v163, s[4:7], s66 offen offset:3072 sc1 lds
s_add_u32 m0, s64, 16384
s_nop 0
buffer_load_dwordx4 v164, s[12:15], s67 offen offset:0 lds
buffer_load_dwordx4 v165, s[12:15], s67 offen offset:1024 lds
buffer_load_dwordx4 v166, s[12:15], s67 offen offset:2048 lds
buffer_load_dwordx4 v167, s[12:15], s67 offen offset:3072 lds
s_add_u32 s66, s66, 128
s_lshl_b32 s65, s53, 6
s_add_u32 s67, s67, s65
s_add_u32 s59, s59, 1
s_and_b32 s64, s59, 3
s_lshl_b32 s64, s64, 15
s_lshl_b32 s65, s24, 12
s_add_u32 s64, s64, s65
s_mov_b32 m0, s64
s_nop 0
buffer_load_dwordx4 v160, s[4:7], s66 offen offset:0 sc1 lds
buffer_load_dwordx4 v161, s[4:7], s66 offen offset:1024 sc1 lds
buffer_load_dwordx4 v162, s[4:7], s66 offen offset:2048 sc1 lds
buffer_load_dwordx4 v163, s[4:7], s66 offen offset:3072 sc1 lds
s_add_u32 m0, s64, 16384
s_nop 0
buffer_load_dwordx4 v164, s[12:15], s67 offen offset:0 lds
buffer_load_dwordx4 v165, s[12:15], s67 offen offset:1024 lds
buffer_load_dwordx4 v166, s[12:15], s67 offen offset:2048 lds
buffer_load_dwordx4 v167, s[12:15], s67 offen offset:3072 lds
s_add_u32 s66, s66, 128
s_lshl_b32 s65, s53, 6
s_add_u32 s67, s67, s65
s_add_u32 s59, s59, 1
s_cmp_eq_u32 s55, 1
s_cbranch_scc1 WG_NS
s_waitcnt vmcnt(16)
s_barrier
s_and_b32 s64, s58, 3
s_lshl_b32 s64, s64, 15
v_add_u32 v173, s64, v168
v_add_u32 v174, s64, v169
v_add_u32 v175, s64, v170
v_add_u32 v176, s64, v171
v_add_u32 v177, s64, v172
ds_read_b128 v[128:131], v173 offset:0
ds_read_b128 v[132:135], v173 offset:4096
ds_read_b64_tr_b16 v[136:137], v177 offset:0
ds_read_b64_tr_b16 v[138:139], v177 offset:512
ds_read_b64_tr_b16 v[140:141], v177 offset:8192
ds_read_b64_tr_b16 v[142:143], v177 offset:8704
s_and_b32 s64, s59, 3
s_lshl_b32 s64, s64, 15
s_lshl_b32 s65, s24, 12
s_add_u32 s64, s64, s65
s_mov_b32 m0, s64
s_nop 0
buffer_load_dwordx4 v160, s[4:7], s66 offen offset:0 sc1 lds
buffer_load_dwordx4 v161, s[4:7], s66 offen offset:1024 sc1 lds
buffer_load_dwordx4 v162, s[4:7], s66 offen offset:2048 sc1 lds
buffer_load_dwordx4 v163, s[4:7], s66 offen offset:3072 sc1 lds
s_add_u32 m0, s64, 16384
s_nop 0
buffer_load_dwordx4 v164, s[12:15], s67 offen offset:0 lds
buffer_load_dwordx4 v165, s[12:15], s67 offen offset:1024 lds
buffer_load_dwordx4 v166, s[12:15], s67 offen offset:2048 lds
buffer_load_dwordx4 v167, s[12:15], s67 offen offset:3072 lds
s_add_u32 s66, s66, 128
s_lshl_b32 s65, s53, 6
s_add_u32 s67, s67, s65
s_add_u32 s59, s59, 1
ds_read_b128 v[144:147], v174 offset:0
ds_read_b128 v[148:151], v174 offset:4096
ds_read_b64_tr_b16 v[152:153], v177 offset:2048
ds_read_b64_tr_b16 v[154:155], v177 offset:2560
ds_read_b64_tr_b16 v[156:157], v177 offset:10240
ds_read_b64_tr_b16 v[158:159], v177 offset:10752
s_waitcnt lgkmcnt(6)
v_mfma_f32_32x32x16_bf16 v[64:79], v[136:139], v[128:131], 0
v_mfma_f32_32x32x16_bf16 v[80:95], v[140:143], v[128:131], 0
v_mfma_f32_32x32x16_bf16 v[96:111], v[136:139], v[132:135], 0
v_mfma_f32_32x32x16_bf16 v[112:127], v[140:143], v[132:135], 0
ds_read_b128 v[128:131], v175 offset:0
ds_read_b128 v[132:135], v175 offset:4096
ds_read_b64_tr_b16 v[136:137], v177 offset:4096
ds_read_b64_tr_b16 v[138:139], v177 offset:4608
ds_read_b64_tr_b16 v[140:141], v177 offset:12288
ds_read_b64_tr_b16 v[142:143], v177 offset:12800
s_waitcnt lgkmcnt(6)
v_mfma_f32_32x32x16_bf16 v[64:79], v[152:155], v[144:147], v[64:79]
v_mfma_f32_32x32x16_bf16 v[80:95], v[156:159], v[144:147], v[80:95]
v_mfma_f32_32x32x16_bf16 v[96:111], v[152:155], v[148:151], v[96:111]
v_mfma_f32_32x32x16_bf16 v[112:127], v[156:159], v[148:151], v[112:127]
ds_read_b128 v[144:147], v176 offset:0
ds_read_b128 v[148:151], v176 offset:4096
ds_read_b64_tr_b16 v[152:153], v177 offset:6144
ds_read_b64_tr_b16 v[154:155], v177 offset:6656
ds_read_b64_tr_b16 v[156:157], v177 offset:14336
ds_read_b64_tr_b16 v[158:159], v177 offset:14848
s_waitcnt lgkmcnt(6)
v_mfma_f32_32x32x16_bf16 v[64:79], v[136:139], v[128:131], v[64:79]
v_mfma_f32_32x32x16_bf16 v[80:95], v[140:143], v[128:131], v[80:95]
v_mfma_f32_32x32x16_bf16 v[96:111], v[136:139], v[132:135], v[96:111]
v_mfma_f32_32x32x16_bf16 v[112:127], v[140:143], v[132:135], v[112:127]
s_waitcnt lgkmcnt(0)
s_add_u32 s58, s58, 1
GL_42:
s_waitcnt vmcnt(16)
s_barrier
s_and_b32 s64, s58, 3
s_lshl_b32 s64, s64, 15
v_add_u32 v173, s64, v168
v_add_u32 v174, s64, v169
v_add_u32 v175, s64, v170
v_add_u32 v176, s64, v171
v_add_u32 v177, s64, v172
ds_read_b128 v[128:131], v173 offset:0
ds_read_b128 v[132:135], v173 offset:4096
ds_read_b64_tr_b16 v[136:137], v177 offset:0
ds_read_b64_tr_b16 v[138:139], v177 offset:512
ds_read_b64_tr_b16 v[140:141], v177 offset:8192
ds_read_b64_tr_b16 v[142:143], v177 offset:8704
s_and_b32 s64, s59, 3
s_lshl_b32 s64, s64, 15
s_lshl_b32 s65, s24, 12
s_add_u32 s64, s64, s65
s_mov_b32 m0, s64
s_nop 0
buffer_load_dwordx4 v160, s[4:7], s66 offen offset:0 sc1 lds
buffer_load_dwordx4 v161, s[4:7], s66 offen offset:1024 sc1 lds
buffer_load_dwordx4 v162, s[4:7], s66 offen offset:2048 sc1 lds
buffer_load_dwordx4 v163, s[4:7], s66 offen offset:3072 sc1 lds
s_add_u32 m0, s64, 16384
s_nop 0
buffer_load_dwordx4 v164, s[12:15], s67 offen offset:0 lds
buffer_load_dwordx4 v165, s[12:15], s67 offen offset:1024 lds
buffer_load_dwordx4 v166, s[12:15], s67 offen offset:2048 lds
buffer_load_dwordx4 v167, s[12:15], s67 offen offset:3072 lds
s_add_u32 s66, s66, 128
s_lshl_b32 s65, s53, 6
s_add_u32 s67, s67, s65
s_add_u32 s59, s59, 1
v_mfma_f32_32x32x16_bf16 v[64:79], v[152:155], v[144:147], v[64:79]
v_mfma_f32_32x32x16_bf16 v[80:95], v[156:159], v[144:147], v[80:95]
v_mfma_f32_32x32x16_bf16 v[96:111], v[152:155], v[148:151], v[96:111]
v_mfma_f32_32x32x16_bf16 v[112:127], v[156:159], v[148:151], v[112:127]
ds_read_b128 v[144:147], v174 offset:0
ds_read_b128 v[148:151], v174 offset:4096
ds_read_b64_tr_b16 v[152:153], v177 offset:2048
ds_read_b64_tr_b16 v[154:155], v177 offset:2560
ds_read_b64_tr_b16 v[156:157], v177 offset:10240
ds_read_b64_tr_b16 v[158:159], v177 offset:10752
s_waitcnt lgkmcnt(6)
v_mfma_f32_32x32x16_bf16 v[64:79], v[136:139], v[128:131], v[64:79]
v_mfma_f32_32x32x16_bf16 v[80:95], v[140:143], v[128:131], v[80:95]
v_mfma_f32_32x32x16_bf16 v[96:111], v[136:139], v[132:135], v[96:111]
v_mfma_f32_32x32x16_bf16 v[112:127], v[140:143], v[132:135], v[112:127]
ds_read_b128 v[128:131], v175 offset:0
ds_read_b128 v[132:135], v175 offset:4096
ds_read_b64_tr_b16 v[136:137], v177 offset:4096
ds_read_b64_tr_b16 v[138:139], v177 offset:4608
ds_read_b64_tr_b16 v[140:141], v177 offset:12288
ds_read_b64_tr_b16 v[142:143], v177 offset:12800
s_waitcnt lgkmcnt(6)
v_mfma_f32_32x32x16_bf16 v[64:79], v[152:155], v[144:147], v[64:79]
v_mfma_f32_32x32x16_bf16 v[80:95], v[156:159], v[144:147], v[80:95]
v_mfma_f32_32x32x16_bf16 v[96:111], v[152:155], v[148:151], v[96:111]
v_mfma_f32_32x32x16_bf16 v[112:127], v[156:159], v[148:151], v[112:127]
ds_read_b128 v[144:147], v176 offset:0
ds_read_b128 v[148:151], v176 offset:4096
ds_read_b64_tr_b16 v[152:153], v177 offset:6144
ds_read_b64_tr_b16 v[154:155], v177 offset:6656
ds_read_b64_tr_b16 v[156:157], v177 offset:14336
ds_read_b64_tr_b16 v[158:159], v177 offset:14848
s_waitcnt lgkmcnt(6)
v_mfma_f32_32x32x16_bf16 v[64:79], v[136:139], v[128:131], v[64:79]
v_mfma_f32_32x32x16_bf16 v[80:95], v[140:143], v[128:131], v[80:95]
v_mfma_f32_32x32x16_bf16 v[96:111], v[136:139], v[132:135], v[96:111]
v_mfma_f32_32x32x16_bf16 v[112:127], v[140:143], v[132:135], v[112:127]
s_waitcnt lgkmcnt(0)
s_add_u32 s58, s58, 1
s_cmp_lt_u32 s59, s54
s_cbranch_scc1 GL_42
s_waitcnt vmcnt(16)
s_barrier
s_and_b32 s64, s58, 3
s_lshl_b32 s64, s64, 15
v_add_u32 v173, s64, v168
v_add_u32 v174, s64, v169
v_add_u32 v175, s64, v170
v_add_u32 v176, s64, v171
v_add_u32 v177, s64, v172
ds_read_b128 v[128:131], v173 offset:0
ds_read_b128 v[132:135], v173 offset:4096
ds_read_b64_tr_b16 v[136:137], v177 offset:0
ds_read_b64_tr_b16 v[138:139], v177 offset:512
ds_read_b64_tr_b16 v[140:141], v177 offset:8192
ds_read_b64_tr_b16 v[142:143], v177 offset:8704
v_mfma_f32_32x32x16_bf16 v[64:79], v[152:155], v[144:147], v[64:79]
v_mfma_f32_32x32x16_bf16 v[80:95], v[156:159], v[144:147], v[80:95]
v_mfma_f32_32x32x16_bf16 v[96:111], v[152:155], v[148:151], v[96:111]
v_mfma_f32_32x32x16_bf16 v[112:127], v[156:159], v[148:151], v[112:127]
ds_read_b128 v[144:147], v174 offset:0
ds_read_b128 v[148:151], v174 offset:4096
ds_read_b64_tr_b16 v[152:153], v177 offset:2048
ds_read_b64_tr_b16 v[154:155], v177 offset:2560
ds_read_b64_tr_b16 v[156:157], v177 offset:10240
ds_read_b64_tr_b16 v[158:159], v177 offset:10752
s_waitcnt lgkmcnt(6)
v_mfma_f32_32x32x16_bf16 v[64:79], v[136:139], v[128:131], v[64:79]
v_mfma_f32_32x32x16_bf16 v[80:95], v[140:143], v[128:131], v[80:95]
v_mfma_f32_32x32x16_bf16 v[96:111], v[136:139], v[132:135], v[96:111]
v_mfma_f32_32x32x16_bf16 v[112:127], v[140:143], v[132:135], v[112:127]
ds_read_b128 v[128:131], v175 offset:0
ds_read_b128 v[132:135], v175 offset:4096
ds_read_b64_tr_b16 v[136:137], v177 offset:4096
ds_read_b64_tr_b16 v[138:139], v177 offset:4608
ds_read_b64_tr_b16 v[140:141], v177 offset:12288
ds_read_b64_tr_b16 v[142:143], v177 offset:12800
s_waitcnt lgkmcnt(6)
v_mfma_f32_32x32x16_bf16 v[64:79], v[152:155], v[144:147], v[64:79]
v_mfma_f32_32x32x16_bf16 v[80:95], v[156:159], v[144:147], v[80:95]
v_mfma_f32_32x32x16_bf16 v[96:111], v[152:155], v[148:151], v[96:111]
v_mfma_f32_32x32x16_bf16 v[112:127], v[156:159], v[148:151], v[112:127]
ds_read_b128 v[144:147], v176 offset:0
ds_read_b128 v[148:151], v176 offset:4096
ds_read_b64_tr_b16 v[152:153], v177 offset:6144
ds_read_b64_tr_b16 v[154:155], v177 offset:6656
ds_read_b64_tr_b16 v[156:157], v177 offset:14336
ds_read_b64_tr_b16 v[158:159], v177 offset:14848
s_waitcnt lgkmcnt(6)
v_mfma_f32_32x32x16_bf16 v[64:79], v[136:139], v[128:131], v[64:79]
v_mfma_f32_32x32x16_bf16 v[80:95], v[140:143], v[128:131], v[80:95]
v_mfma_f32_32x32x16_bf16 v[96:111], v[136:139], v[132:135], v[96:111]
v_mfma_f32_32x32x16_bf16 v[112:127], v[140:143], v[132:135], v[112:127]
s_waitcnt lgkmcnt(0)
s_add_u32 s58, s58, 1
s_waitcnt vmcnt(8)
s_barrier
s_and_b32 s64, s58, 3
s_lshl_b32 s64, s64, 15
v_add_u32 v173, s64, v168
v_add_u32 v174, s64, v169
v_add_u32 v175, s64, v170
v_add_u32 v176, s64, v171
v_add_u32 v177, s64, v172
ds_read_b128 v[128:131], v173 offset:0
ds_read_b128 v[132:135], v173 offset:4096
ds_read_b64_tr_b16 v[136:137], v177 offset:0
ds_read_b64_tr_b16 v[138:139], v177 offset:512
ds_read_b64_tr_b16 v[140:141], v177 offset:8192
ds_read_b64_tr_b16 v[142:143], v177 offset:8704
v_mfma_f32_32x32x16_bf16 v[64:79], v[152:155], v[144:147], v[64:79]
v_mfma_f32_32x32x16_bf16 v[80:95], v[156:159], v[144:147], v[80:95]
v_mfma_f32_32x32x16_bf16 v[96:111], v[152:155], v[148:151], v[96:111]
v_mfma_f32_32x32x16_bf16 v[112:127], v[156:159], v[148:151], v[112:127]
ds_read_b128 v[144:147], v174 offset:0
ds_read_b128 v[148:151], v174 offset:4096
ds_read_b64_tr_b16 v[152:153], v177 offset:2048
ds_read_b64_tr_b16 v[154:155], v177 offset:2560
ds_read_b64_tr_b16 v[156:157], v177 offset:10240
ds_read_b64_tr_b16 v[158:159], v177 offset:10752
s_waitcnt lgkmcnt(6)
v_mfma_f32_32x32x16_bf16 v[64:79], v[136:139], v[128:131], v[64:79]
v_mfma_f32_32x32x16_bf16 v[80:95], v[140:143], v[128:131], v[80:95]
v_mfma_f32_32x32x16_bf16 v[96:111], v[136:139], v[132:135], v[96:111]
v_mfma_f32_32x32x16_bf16 v[112:127], v[140:143], v[132:135], v[112:127]
ds_read_b128 v[128:131], v175 offset:0
ds_read_b128 v[132:135], v175 offset:4096
ds_read_b64_tr_b16 v[136:137], v177 offset:4096
ds_read_b64_tr_b16 v[138:139], v177 offset:4608
ds_read_b64_tr_b16 v[140:141], v177 offset:12288
ds_read_b64_tr_b16 v[142:143], v177 offset:12800
s_waitcnt lgkmcnt(6)
v_mfma_f32_32x32x16_bf16 v[64:79], v[152:155], v[144:147], v[64:79]
v_mfma_f32_32x32x16_bf16 v[80:95], v[156:159], v[144:147], v[80:95]
v_mfma_f32_32x32x16_bf16 v[96:111], v[152:155], v[148:151], v[96:111]
v_mfma_f32_32x32x16_bf16 v[112:127], v[156:159], v[148:151], v[112:127]
ds_read_b128 v[144:147], v176 offset:0
ds_read_b128 v[148:151], v176 offset:4096
ds_read_b64_tr_b16 v[152:153], v177 offset:6144
ds_read_b64_tr_b16 v[154:155], v177 offset:6656
ds_read_b64_tr_b16 v[156:157], v177 offset:14336
ds_read_b64_tr_b16 v[158:159], v177 offset:14848
s_waitcnt lgkmcnt(6)
v_mfma_f32_32x32x16_bf16 v[64:79], v[136:139], v[128:131], v[64:79]
v_mfma_f32_32x32x16_bf16 v[80:95], v[140:143], v[128:131], v[80:95]
v_mfma_f32_32x32x16_bf16 v[96:111], v[136:139], v[132:135], v[96:111]
v_mfma_f32_32x32x16_bf16 v[112:127], v[140:143], v[132:135], v[112:127]
s_waitcnt lgkmcnt(0)
s_add_u32 s58, s58, 1
s_waitcnt vmcnt(0)
s_barrier
s_and_b32 s64, s58, 3
s_lshl_b32 s64, s64, 15
v_add_u32 v173, s64, v168
v_add_u32 v174, s64, v169
v_add_u32 v175, s64, v170
v_add_u32 v176, s64, v171
v_add_u32 v177, s64, v172
ds_read_b128 v[128:131], v173 offset:0
ds_read_b128 v[132:135], v173 offset:4096
ds_read_b64_tr_b16 v[136:137], v177 offset:0
ds_read_b64_tr_b16 v[138:139], v177 offset:512
ds_read_b64_tr_b16 v[140:141], v177 offset:8192
ds_read_b64_tr_b16 v[142:143], v177 offset:8704
v_mfma_f32_32x32x16_bf16 v[64:79], v[152:155], v[144:147], v[64:79]
v_mfma_f32_32x32x16_bf16 v[80:95], v[156:159], v[144:147], v[80:95]
v_mfma_f32_32x32x16_bf16 v[96:111], v[152:155], v[148:151], v[96:111]
v_mfma_f32_32x32x16_bf16 v[112:127], v[156:159], v[148:151], v[112:127]
ds_read_b128 v[144:147], v174 offset:0
ds_read_b128 v[148:151], v174 offset:4096
ds_read_b64_tr_b16 v[152:153], v177 offset:2048
ds_read_b64_tr_b16 v[154:155], v177 offset:2560
ds_read_b64_tr_b16 v[156:157], v177 offset:10240
ds_read_b64_tr_b16 v[158:159], v177 offset:10752
s_waitcnt lgkmcnt(6)
v_mfma_f32_32x32x16_bf16 v[64:79], v[136:139], v[128:131], v[64:79]
v_mfma_f32_32x32x16_bf16 v[80:95], v[140:143], v[128:131], v[80:95]
v_mfma_f32_32x32x16_bf16 v[96:111], v[136:139], v[132:135], v[96:111]
v_mfma_f32_32x32x16_bf16 v[112:127], v[140:143], v[132:135], v[112:127]
ds_read_b128 v[128:131], v175 offset:0
ds_read_b128 v[132:135], v175 offset:4096
ds_read_b64_tr_b16 v[136:137], v177 offset:4096
ds_read_b64_tr_b16 v[138:139], v177 offset:4608
ds_read_b64_tr_b16 v[140:141], v177 offset:12288
ds_read_b64_tr_b16 v[142:143], v177 offset:12800
s_waitcnt lgkmcnt(6)
v_mfma_f32_32x32x16_bf16 v[64:79], v[152:155], v[144:147], v[64:79]
v_mfma_f32_32x32x16_bf16 v[80:95], v[156:159], v[144:147], v[80:95]
v_mfma_f32_32x32x16_bf16 v[96:111], v[152:155], v[148:151], v[96:111]
v_mfma_f32_32x32x16_bf16 v[112:127], v[156:159], v[148:151], v[112:127]
ds_read_b128 v[144:147], v176 offset:0
ds_read_b128 v[148:151], v176 offset:4096
ds_read_b64_tr_b16 v[152:153], v177 offset:6144
ds_read_b64_tr_b16 v[154:155], v177 offset:6656
ds_read_b64_tr_b16 v[156:157], v177 offset:14336
ds_read_b64_tr_b16 v[158:159], v177 offset:14848
s_waitcnt lgkmcnt(6)
v_mfma_f32_32x32x16_bf16 v[64:79], v[136:139], v[128:131], v[64:79]
v_mfma_f32_32x32x16_bf16 v[80:95], v[140:143], v[128:131], v[80:95]
v_mfma_f32_32x32x16_bf16 v[96:111], v[136:139], v[132:135], v[96:111]
v_mfma_f32_32x32x16_bf16 v[112:127], v[140:143], v[132:135], v[112:127]
s_waitcnt lgkmcnt(0)
s_add_u32 s58, s58, 1
v_mfma_f32_32x32x16_bf16 v[64:79], v[152:155], v[144:147], v[64:79]
v_mfma_f32_32x32x16_bf16 v[80:95], v[156:159], v[144:147], v[80:95]
v_mfma_f32_32x32x16_bf16 v[96:111], v[152:155], v[148:151], v[96:111]
v_mfma_f32_32x32x16_bf16 v[112:127], v[156:159], v[148:151], v[112:127]
s_cmp_eq_u32 s55, 3
s_cbranch_scc1 WE_F1
s_cmp_eq_u32 s55, 4
s_cbranch_scc1 WE_F2
v_bfe_u32 v2, v0, 4, 1
v_lshlrev_b32 v2, 10, v2
v_lshrrev_b32 v3, 5, v0
v_lshl_add_u32 v2, v3, 8, v2
v_and_b32 v3, 15, v0
v_lshl_add_u32 v2, v3, 4, v2
s_and_b32 s28, s24, 1
s_lshl_b32 s28, s28, 11
v_add_u32 v2, s28, v2
s_lshl_b32 s28, s56, 2
s_and_b32 s29, s24, 2
s_add_u32 s28, s28, s29
s_lshl_b32 s28, s28, 5
s_add_u32 s28, s28, s57
s_lshl_b32 s28, s28, 13
s_add_u32 s28, s28, s68
v_cvt_pk_bf16_f32 v8, v64, v65
v_cvt_pk_bf16_f32 v9, v66, v67
v_cvt_pk_bf16_f32 v10, v68, v69
v_cvt_pk_bf16_f32 v11, v70, v71
v_cvt_pk_bf16_f32 v12, v72, v73
v_cvt_pk_bf16_f32 v13, v74, v75
v_cvt_pk_bf16_f32 v14, v76, v77
v_cvt_pk_bf16_f32 v15, v78, v79
v_permlane32_swap_b32 v8, v10
v_permlane32_swap_b32 v9, v11
v_permlane32_swap_b32 v12, v14
v_permlane32_swap_b32 v13, v15
s_add_u32 s29, s28, 0
buffer_store_dwordx4 v[8:11], v2, s[4:7], s29 offen offset:0 sc1
buffer_store_dwordx4 v[12:15], v2, s[4:7], s29 offen offset:512 sc1
v_cvt_pk_bf16_f32 v16, v80, v81
v_cvt_pk_bf16_f32 v17, v82, v83
v_cvt_pk_bf16_f32 v18, v84, v85
v_cvt_pk_bf16_f32 v19, v86, v87
v_cvt_pk_bf16_f32 v20, v88, v89
v_cvt_pk_bf16_f32 v21, v90, v91
v_cvt_pk_bf16_f32 v22, v92, v93
v_cvt_pk_bf16_f32 v23, v94, v95
v_permlane32_swap_b32 v16, v18
v_permlane32_swap_b32 v17, v19
v_permlane32_swap_b32 v20, v22
v_permlane32_swap_b32 v21, v23
s_add_u32 s29, s28, 4096
buffer_store_dwordx4 v[16:19], v2, s[4:7], s29 offen offset:0 sc1
buffer_store_dwordx4 v[20:23], v2, s[4:7], s29 offen offset:512 sc1
v_cvt_pk_bf16_f32 v24, v96, v97
v_cvt_pk_bf16_f32 v25, v98, v99
v_cvt_pk_bf16_f32 v26, v100, v101
v_cvt_pk_bf16_f32 v27, v102, v103
v_cvt_pk_bf16_f32 v28, v104, v105
v_cvt_pk_bf16_f32 v29, v106, v107
v_cvt_pk_bf16_f32 v30, v108, v109
v_cvt_pk_bf16_f32 v31, v110, v111
v_permlane32_swap_b32 v24, v26
v_permlane32_swap_b32 v25, v27
v_permlane32_swap_b32 v28, v30
v_permlane32_swap_b32 v29, v31
s_add_u32 s29, s28, 262144
buffer_store_dwordx4 v[24:27], v2, s[4:7], s29 offen offset:0 sc1
buffer_store_dwordx4 v[28:31], v2, s[4:7], s29 offen offset:512 sc1
v_cvt_pk_bf16_f32 v32, v112, v113
v_cvt_pk_bf16_f32 v33, v114, v115
v_cvt_pk_bf16_f32 v34, v116, v117
v_cvt_pk_bf16_f32 v35, v118, v119
v_cvt_pk_bf16_f32 v36, v120, v121
v_cvt_pk_bf16_f32 v37, v122, v123
v_cvt_pk_bf16_f32 v38, v124, v125
v_cvt_pk_bf16_f32 v39, v126, v127
v_permlane32_swap_b32 v32, v34
v_permlane32_swap_b32 v33, v35
v_permlane32_swap_b32 v36, v38
v_permlane32_swap_b32 v37, v39
s_add_u32 s29, s28, 266240
buffer_store_dwordx4 v[32:35], v2, s[4:7], s29 offen offset:0 sc1
buffer_store_dwordx4 v[36:39], v2, s[4:7], s29 offen offset:512 sc1
s_cmp_eq_u32 s55, 0
s_mov_b32 s30, 5120
s_cselect_b32 s30, 1024, s30
s_branch WE_SIG
WG_NS:
s_waitcnt vmcnt(16)
s_barrier
s_and_b32 s64, s58, 3
s_lshl_b32 s64, s64, 15
v_add_u32 v173, s64, v168
v_add_u32 v174, s64, v169
v_add_u32 v175, s64, v170
v_add_u32 v176, s64, v171
v_add_u32 v177, s64, v172
ds_read_b128 v[128:131], v173 offset:0
ds_read_b128 v[132:135], v173 offset:4096
ds_read_b64_tr_b16 v[136:137], v177 offset:0
ds_read_b64_tr_b16 v[138:139], v177 offset:512
ds_read_b64_tr_b16 v[140:141], v177 offset:8192
ds_read_b64_tr_b16 v[142:143], v177 offset:8704
s_and_b32 s64, s59, 3
s_lshl_b32 s64, s64, 15
s_lshl_b32 s65, s24, 12
s_add_u32 s64, s64, s65
s_mov_b32 m0, s64
s_nop 0
buffer_load_dwordx4 v160, s[4:7], s66 offen offset:0 sc1 lds
buffer_load_dwordx4 v161, s[4:7], s66 offen offset:1024 sc1 lds
buffer_load_dwordx4 v162, s[4:7], s66 offen offset:2048 sc1 lds
buffer_load_dwordx4 v163, s[4:7], s66 offen offset:3072 sc1 lds
s_add_u32 m0, s64, 16384
s_nop 0
buffer_load_dwordx4 v164, s[12:15], s67 offen offset:0 lds
buffer_load_dwordx4 v165, s[12:15], s67 offen offset:1024 lds
buffer_load_dwordx4 v166, s[12:15], s67 offen offset:2048 lds
buffer_load_dwordx4 v167, s[12:15], s67 offen offset:3072 lds
s_add_u32 s66, s66, 128
s_lshl_b32 s65, s53, 6
s_add_u32 s67, s67, s65
s_add_u32 s59, s59, 1
ds_read_b128 v[144:147], v174 offset:0
ds_read_b128 v[148:151], v174 offset:4096
ds_read_b64_tr_b16 v[152:153], v177 offset:2048
ds_read_b64_tr_b16 v[154:155], v177 offset:2560
ds_read_b64_tr_b16 v[156:157], v177 offset:10240
ds_read_b64_tr_b16 v[158:159], v177 offset:10752
s_waitcnt lgkmcnt(6)
v_mfma_f32_32x32x16_bf16 v[64:79], v[128:131], v[136:139], 0
v_mfma_f32_32x32x16_bf16 v[80:95], v[128:131], v[140:143], 0
v_mfma_f32_32x32x16_bf16 v[96:111], v[132:135], v[136:139], 0
v_mfma_f32_32x32x16_bf16 v[112:127], v[132:135], v[140:143], 0
ds_read_b128 v[128:131], v175 offset:0
ds_read_b128 v[132:135], v175 offset:4096
ds_read_b64_tr_b16 v[136:137], v177 offset:4096
ds_read_b64_tr_b16 v[138:139], v177 offset:4608
ds_read_b64_tr_b16 v[140:141], v177 offset:12288
ds_read_b64_tr_b16 v[142:143], v177 offset:12800
s_waitcnt lgkmcnt(6)
v_mfma_f32_32x32x16_bf16 v[64:79], v[144:147], v[152:155], v[64:79]
v_mfma_f32_32x32x16_bf16 v[80:95], v[144:147], v[156:159], v[80:95]
v_mfma_f32_32x32x16_bf16 v[96:111], v[148:151], v[152:155], v[96:111]
v_mfma_f32_32x32x16_bf16 v[112:127], v[148:151], v[156:159], v[112:127]
ds_read_b128 v[144:147], v176 offset:0
ds_read_b128 v[148:151], v176 offset:4096
ds_read_b64_tr_b16 v[152:153], v177 offset:6144
ds_read_b64_tr_b16 v[154:155], v177 offset:6656
ds_read_b64_tr_b16 v[156:157], v177 offset:14336
ds_read_b64_tr_b16 v[158:159], v177 offset:14848
s_waitcnt lgkmcnt(6)
v_mfma_f32_32x32x16_bf16 v[64:79], v[128:131], v[136:139], v[64:79]
v_mfma_f32_32x32x16_bf16 v[80:95], v[128:131], v[140:143], v[80:95]
v_mfma_f32_32x32x16_bf16 v[96:111], v[132:135], v[136:139], v[96:111]
v_mfma_f32_32x32x16_bf16 v[112:127], v[132:135], v[140:143], v[112:127]
s_waitcnt lgkmcnt(0)
s_add_u32 s58, s58, 1
GL_43:
s_waitcnt vmcnt(16)
s_barrier
s_and_b32 s64, s58, 3
s_lshl_b32 s64, s64, 15
v_add_u32 v173, s64, v168
v_add_u32 v174, s64, v169
v_add_u32 v175, s64, v170
v_add_u32 v176, s64, v171
v_add_u32 v177, s64, v172
ds_read_b128 v[128:131], v173 offset:0
ds_read_b128 v[132:135], v173 offset:4096
ds_read_b64_tr_b16 v[136:137], v177 offset:0
ds_read_b64_tr_b16 v[138:139], v177 offset:512
ds_read_b64_tr_b16 v[140:141], v177 offset:8192
ds_read_b64_tr_b16 v[142:143], v177 offset:8704
s_and_b32 s64, s59, 3
s_lshl_b32 s64, s64, 15
s_lshl_b32 s65, s24, 12
s_add_u32 s64, s64, s65
s_mov_b32 m0, s64
s_nop 0
buffer_load_dwordx4 v160, s[4:7], s66 offen offset:0 sc1 lds
buffer_load_dwordx4 v161, s[4:7], s66 offen offset:1024 sc1 lds
buffer_load_dwordx4 v162, s[4:7], s66 offen offset:2048 sc1 lds
buffer_load_dwordx4 v163, s[4:7], s66 offen offset:3072 sc1 lds
s_add_u32 m0, s64, 16384
s_nop 0
buffer_load_dwordx4 v164, s[12:15], s67 offen offset:0 lds
buffer_load_dwordx4 v165, s[12:15], s67 offen offset:1024 lds
buffer_load_dwordx4 v166, s[12:15], s67 offen offset:2048 lds
buffer_load_dwordx4 v167, s[12:15], s67 offen offset:3072 lds
s_add_u32 s66, s66, 128
s_lshl_b32 s65, s53, 6
s_add_u32 s67, s67, s65
s_add_u32 s59, s59, 1
v_mfma_f32_32x32x16_bf16 v[64:79], v[144:147], v[152:155], v[64:79]
v_mfma_f32_32x32x16_bf16 v[80:95], v[144:147], v[156:159], v[80:95]
v_mfma_f32_32x32x16_bf16 v[96:111], v[148:151], v[152:155], v[96:111]
v_mfma_f32_32x32x16_bf16 v[112:127], v[148:151], v[156:159], v[112:127]
ds_read_b128 v[144:147], v174 offset:0
ds_read_b128 v[148:151], v174 offset:4096
ds_read_b64_tr_b16 v[152:153], v177 offset:2048
ds_read_b64_tr_b16 v[154:155], v177 offset:2560
ds_read_b64_tr_b16 v[156:157], v177 offset:10240
ds_read_b64_tr_b16 v[158:159], v177 offset:10752
s_waitcnt lgkmcnt(6)
v_mfma_f32_32x32x16_bf16 v[64:79], v[128:131], v[136:139], v[64:79]
v_mfma_f32_32x32x16_bf16 v[80:95], v[128:131], v[140:143], v[80:95]
v_mfma_f32_32x32x16_bf16 v[96:111], v[132:135], v[136:139], v[96:111]
v_mfma_f32_32x32x16_bf16 v[112:127], v[132:135], v[140:143], v[112:127]
ds_read_b128 v[128:131], v175 offset:0
ds_read_b128 v[132:135], v175 offset:4096
ds_read_b64_tr_b16 v[136:137], v177 offset:4096
ds_read_b64_tr_b16 v[138:139], v177 offset:4608
ds_read_b64_tr_b16 v[140:141], v177 offset:12288
ds_read_b64_tr_b16 v[142:143], v177 offset:12800
s_waitcnt lgkmcnt(6)
v_mfma_f32_32x32x16_bf16 v[64:79], v[144:147], v[152:155], v[64:79]
v_mfma_f32_32x32x16_bf16 v[80:95], v[144:147], v[156:159], v[80:95]
v_mfma_f32_32x32x16_bf16 v[96:111], v[148:151], v[152:155], v[96:111]
v_mfma_f32_32x32x16_bf16 v[112:127], v[148:151], v[156:159], v[112:127]
ds_read_b128 v[144:147], v176 offset:0
ds_read_b128 v[148:151], v176 offset:4096
ds_read_b64_tr_b16 v[152:153], v177 offset:6144
ds_read_b64_tr_b16 v[154:155], v177 offset:6656
ds_read_b64_tr_b16 v[156:157], v177 offset:14336
ds_read_b64_tr_b16 v[158:159], v177 offset:14848
s_waitcnt lgkmcnt(6)
v_mfma_f32_32x32x16_bf16 v[64:79], v[128:131], v[136:139], v[64:79]
v_mfma_f32_32x32x16_bf16 v[80:95], v[128:131], v[140:143], v[80:95]
v_mfma_f32_32x32x16_bf16 v[96:111], v[132:135], v[136:139], v[96:111]
v_mfma_f32_32x32x16_bf16 v[112:127], v[132:135], v[140:143], v[112:127]
s_waitcnt lgkmcnt(0)
s_add_u32 s58, s58, 1
s_cmp_lt_u32 s59, s54
s_cbranch_scc1 GL_43
s_waitcnt vmcnt(16)
s_barrier
s_and_b32 s64, s58, 3
s_lshl_b32 s64, s64, 15
v_add_u32 v173, s64, v168
v_add_u32 v174, s64, v169
v_add_u32 v175, s64, v170
v_add_u32 v176, s64, v171
v_add_u32 v177, s64, v172
ds_read_b128 v[128:131], v173 offset:0
ds_read_b128 v[132:135], v173 offset:4096
ds_read_b64_tr_b16 v[136:137], v177 offset:0
ds_read_b64_tr_b16 v[138:139], v177 offset:512
ds_read_b64_tr_b16 v[140:141], v177 offset:8192
ds_read_b64_tr_b16 v[142:143], v177 offset:8704
v_mfma_f32_32x32x16_bf16 v[64:79], v[144:147], v[152:155], v[64:79]
v_mfma_f32_32x32x16_bf16 v[80:95], v[144:147], v[156:159], v[80:95]
v_mfma_f32_32x32x16_bf16 v[96:111], v[148:151], v[152:155], v[96:111]
v_mfma_f32_32x32x16_bf16 v[112:127], v[148:151], v[156:159], v[112:127]
ds_read_b128 v[144:147], v174 offset:0
ds_read_b128 v[148:151], v174 offset:4096
ds_read_b64_tr_b16 v[152:153], v177 offset:2048
ds_read_b64_tr_b16 v[154:155], v177 offset:2560
ds_read_b64_tr_b16 v[156:157], v177 offset:10240
ds_read_b64_tr_b16 v[158:159], v177 offset:10752
s_waitcnt lgkmcnt(6)
v_mfma_f32_32x32x16_bf16 v[64:79], v[128:131], v[136:139], v[64:79]
v_mfma_f32_32x32x16_bf16 v[80:95], v[128:131], v[140:143], v[80:95]
v_mfma_f32_32x32x16_bf16 v[96:111], v[132:135], v[136:139], v[96:111]
v_mfma_f32_32x32x16_bf16 v[112:127], v[132:135], v[140:143], v[112:127]
ds_read_b128 v[128:131], v175 offset:0
ds_read_b128 v[132:135], v175 offset:4096
ds_read_b64_tr_b16 v[136:137], v177 offset:4096
ds_read_b64_tr_b16 v[138:139], v177 offset:4608
ds_read_b64_tr_b16 v[140:141], v177 offset:12288
ds_read_b64_tr_b16 v[142:143], v177 offset:12800
s_waitcnt lgkmcnt(6)
v_mfma_f32_32x32x16_bf16 v[64:79], v[144:147], v[152:155], v[64:79]
v_mfma_f32_32x32x16_bf16 v[80:95], v[144:147], v[156:159], v[80:95]
v_mfma_f32_32x32x16_bf16 v[96:111], v[148:151], v[152:155], v[96:111]
v_mfma_f32_32x32x16_bf16 v[112:127], v[148:151], v[156:159], v[112:127]
ds_read_b128 v[144:147], v176 offset:0
ds_read_b128 v[148:151], v176 offset:4096
ds_read_b64_tr_b16 v[152:153], v177 offset:6144
ds_read_b64_tr_b16 v[154:155], v177 offset:6656
ds_read_b64_tr_b16 v[156:157], v177 offset:14336
ds_read_b64_tr_b16 v[158:159], v177 offset:14848
s_waitcnt lgkmcnt(6)
v_mfma_f32_32x32x16_bf16 v[64:79], v[128:131], v[136:139], v[64:79]
v_mfma_f32_32x32x16_bf16 v[80:95], v[128:131], v[140:143], v[80:95]
v_mfma_f32_32x32x16_bf16 v[96:111], v[132:135], v[136:139], v[96:111]
v_mfma_f32_32x32x16_bf16 v[112:127], v[132:135], v[140:143], v[112:127]
s_waitcnt lgkmcnt(0)
s_add_u32 s58, s58, 1
s_waitcnt vmcnt(8)
s_barrier
s_and_b32 s64, s58, 3
s_lshl_b32 s64, s64, 15
v_add_u32 v173, s64, v168
v_add_u32 v174, s64, v169
v_add_u32 v175, s64, v170
v_add_u32 v176, s64, v171
v_add_u32 v177, s64, v172
ds_read_b128 v[128:131], v173 offset:0
ds_read_b128 v[132:135], v173 offset:4096
ds_read_b64_tr_b16 v[136:137], v177 offset:0
ds_read_b64_tr_b16 v[138:139], v177 offset:512
ds_read_b64_tr_b16 v[140:141], v177 offset:8192
ds_read_b64_tr_b16 v[142:143], v177 offset:8704
v_mfma_f32_32x32x16_bf16 v[64:79], v[144:147], v[152:155], v[64:79]
v_mfma_f32_32x32x16_bf16 v[80:95], v[144:147], v[156:159], v[80:95]
v_mfma_f32_32x32x16_bf16 v[96:111], v[148:151], v[152:155], v[96:111]
v_mfma_f32_32x32x16_bf16 v[112:127], v[148:151], v[156:159], v[112:127]
ds_read_b128 v[144:147], v174 offset:0
ds_read_b128 v[148:151], v174 offset:4096
ds_read_b64_tr_b16 v[152:153], v177 offset:2048
ds_read_b64_tr_b16 v[154:155], v177 offset:2560
ds_read_b64_tr_b16 v[156:157], v177 offset:10240
ds_read_b64_tr_b16 v[158:159], v177 offset:10752
s_waitcnt lgkmcnt(6)
v_mfma_f32_32x32x16_bf16 v[64:79], v[128:131], v[136:139], v[64:79]
v_mfma_f32_32x32x16_bf16 v[80:95], v[128:131], v[140:143], v[80:95]
v_mfma_f32_32x32x16_bf16 v[96:111], v[132:135], v[136:139], v[96:111]
v_mfma_f32_32x32x16_bf16 v[112:127], v[132:135], v[140:143], v[112:127]
ds_read_b128 v[128:131], v175 offset:0
ds_read_b128 v[132:135], v175 offset:4096
ds_read_b64_tr_b16 v[136:137], v177 offset:4096
ds_read_b64_tr_b16 v[138:139], v177 offset:4608
ds_read_b64_tr_b16 v[140:141], v177 offset:12288
ds_read_b64_tr_b16 v[142:143], v177 offset:12800
s_waitcnt lgkmcnt(6)
v_mfma_f32_32x32x16_bf16 v[64:79], v[144:147], v[152:155], v[64:79]
v_mfma_f32_32x32x16_bf16 v[80:95], v[144:147], v[156:159], v[80:95]
v_mfma_f32_32x32x16_bf16 v[96:111], v[148:151], v[152:155], v[96:111]
v_mfma_f32_32x32x16_bf16 v[112:127], v[148:151], v[156:159], v[112:127]
ds_read_b128 v[144:147], v176 offset:0
ds_read_b128 v[148:151], v176 offset:4096
ds_read_b64_tr_b16 v[152:153], v177 offset:6144
ds_read_b64_tr_b16 v[154:155], v177 offset:6656
ds_read_b64_tr_b16 v[156:157], v177 offset:14336
ds_read_b64_tr_b16 v[158:159], v177 offset:14848
s_waitcnt lgkmcnt(6)
v_mfma_f32_32x32x16_bf16 v[64:79], v[128:131], v[136:139], v[64:79]
v_mfma_f32_32x32x16_bf16 v[80:95], v[128:131], v[140:143], v[80:95]
v_mfma_f32_32x32x16_bf16 v[96:111], v[132:135], v[136:139], v[96:111]
v_mfma_f32_32x32x16_bf16 v[112:127], v[132:135], v[140:143], v[112:127]
s_waitcnt lgkmcnt(0)
s_add_u32 s58, s58, 1
s_waitcnt vmcnt(0)
s_barrier
s_and_b32 s64, s58, 3
s_lshl_b32 s64, s64, 15
v_add_u32 v173, s64, v168
v_add_u32 v174, s64, v169
v_add_u32 v175, s64, v170
v_add_u32 v176, s64, v171
v_add_u32 v177, s64, v172
ds_read_b128 v[128:131], v173 offset:0
ds_read_b128 v[132:135], v173 offset:4096
ds_read_b64_tr_b16 v[136:137], v177 offset:0
ds_read_b64_tr_b16 v[138:139], v177 offset:512
ds_read_b64_tr_b16 v[140:141], v177 offset:8192
ds_read_b64_tr_b16 v[142:143], v177 offset:8704
v_mfma_f32_32x32x16_bf16 v[64:79], v[144:147], v[152:155], v[64:79]
v_mfma_f32_32x32x16_bf16 v[80:95], v[144:147], v[156:159], v[80:95]
v_mfma_f32_32x32x16_bf16 v[96:111], v[148:151], v[152:155], v[96:111]
v_mfma_f32_32x32x16_bf16 v[112:127], v[148:151], v[156:159], v[112:127]
ds_read_b128 v[144:147], v174 offset:0
ds_read_b128 v[148:151], v174 offset:4096
ds_read_b64_tr_b16 v[152:153], v177 offset:2048
ds_read_b64_tr_b16 v[154:155], v177 offset:2560
ds_read_b64_tr_b16 v[156:157], v177 offset:10240
ds_read_b64_tr_b16 v[158:159], v177 offset:10752
s_waitcnt lgkmcnt(6)
v_mfma_f32_32x32x16_bf16 v[64:79], v[128:131], v[136:139], v[64:79]
v_mfma_f32_32x32x16_bf16 v[80:95], v[128:131], v[140:143], v[80:95]
v_mfma_f32_32x32x16_bf16 v[96:111], v[132:135], v[136:139], v[96:111]
v_mfma_f32_32x32x16_bf16 v[112:127], v[132:135], v[140:143], v[112:127]
ds_read_b128 v[128:131], v175 offset:0
ds_read_b128 v[132:135], v175 offset:4096
ds_read_b64_tr_b16 v[136:137], v177 offset:4096
ds_read_b64_tr_b16 v[138:139], v177 offset:4608
ds_read_b64_tr_b16 v[140:141], v177 offset:12288
ds_read_b64_tr_b16 v[142:143], v177 offset:12800
s_waitcnt lgkmcnt(6)
v_mfma_f32_32x32x16_bf16 v[64:79], v[144:147], v[152:155], v[64:79]
v_mfma_f32_32x32x16_bf16 v[80:95], v[144:147], v[156:159], v[80:95]
v_mfma_f32_32x32x16_bf16 v[96:111], v[148:151], v[152:155], v[96:111]
v_mfma_f32_32x32x16_bf16 v[112:127], v[148:151], v[156:159], v[112:127]
ds_read_b128 v[144:147], v176 offset:0
ds_read_b128 v[148:151], v176 offset:4096
ds_read_b64_tr_b16 v[152:153], v177 offset:6144
ds_read_b64_tr_b16 v[154:155], v177 offset:6656
ds_read_b64_tr_b16 v[156:157], v177 offset:14336
ds_read_b64_tr_b16 v[158:159], v177 offset:14848
s_waitcnt lgkmcnt(6)
v_mfma_f32_32x32x16_bf16 v[64:79], v[128:131], v[136:139], v[64:79]
v_mfma_f32_32x32x16_bf16 v[80:95], v[128:131], v[140:143], v[80:95]
v_mfma_f32_32x32x16_bf16 v[96:111], v[132:135], v[136:139], v[96:111]
v_mfma_f32_32x32x16_bf16 v[112:127], v[132:135], v[140:143], v[112:127]
s_waitcnt lgkmcnt(0)
s_add_u32 s58, s58, 1
v_mfma_f32_32x32x16_bf16 v[64:79], v[144:147], v[152:155], v[64:79]
v_mfma_f32_32x32x16_bf16 v[80:95], v[144:147], v[156:159], v[80:95]
v_mfma_f32_32x32x16_bf16 v[96:111], v[148:151], v[152:155], v[96:111]
v_mfma_f32_32x32x16_bf16 v[112:127], v[148:151], v[156:159], v[112:127]
v_bfe_u32 v2, v0, 4, 1
v_lshlrev_b32 v2, 10, v2
v_lshrrev_b32 v3, 5, v0
v_lshl_add_u32 v2, v3, 8, v2
v_and_b32 v3, 15, v0
v_lshl_add_u32 v2, v3, 4, v2
s_and_b32 s28, s24, 1
s_lshl_b32 s28, s28, 11
v_add_u32 v2, s28, v2
s_lshl_b32 s28, s56, 2
s_and_b32 s29, s24, 2
s_add_u32 s28, s28, s29
s_lshl_b32 s28, s28, 5
s_add_u32 s28, s28, s57
s_lshl_b32 s28, s28, 13
s_add_u32 s28, s28, s68
v_cvt_pk_bf16_f32 v8, v64, v65
v_cvt_pk_bf16_f32 v9, v66, v67
v_cvt_pk_bf16_f32 v10, v72, v73
v_cvt_pk_bf16_f32 v11, v74, v75
v_cvt_pk_bf16_f32 v12, v68, v69
v_cvt_pk_bf16_f32 v13, v70, v71
v_cvt_pk_bf16_f32 v14, v76, v77
v_cvt_pk_bf16_f32 v15, v78, v79
s_add_u32 s29, s28, 0
buffer_store_dwordx4 v[8:11], v2, s[4:7], s29 offen offset:0 sc1
buffer_store_dwordx4 v[12:15], v2, s[4:7], s29 offen offset:512 sc1
v_cvt_pk_bf16_f32 v16, v80, v81
v_cvt_pk_bf16_f32 v17, v82, v83
v_cvt_pk_bf16_f32 v18, v88, v89
v_cvt_pk_bf16_f32 v19, v90, v91
v_cvt_pk_bf16_f32 v20, v84, v85
v_cvt_pk_bf16_f32 v21, v86, v87
v_cvt_pk_bf16_f32 v22, v92, v93
v_cvt_pk_bf16_f32 v23, v94, v95
s_add_u32 s29, s28, 4096
buffer_store_dwordx4 v[16:19], v2, s[4:7], s29 offen offset:0 sc1
buffer_store_dwordx4 v[20:23], v2, s[4:7], s29 offen offset:512 sc1
v_cvt_pk_bf16_f32 v24, v96, v97
v_cvt_pk_bf16_f32 v25, v98, v99
v_cvt_pk_bf16_f32 v26, v104, v105
v_cvt_pk_bf16_f32 v27, v106, v107
v_cvt_pk_bf16_f32 v28, v100, v101
v_cvt_pk_bf16_f32 v29, v102, v103
v_cvt_pk_bf16_f32 v30, v108, v109
v_cvt_pk_bf16_f32 v31, v110, v111
s_add_u32 s29, s28, 262144
buffer_store_dwordx4 v[24:27], v2, s[4:7], s29 offen offset:0 sc1
buffer_store_dwordx4 v[28:31], v2, s[4:7], s29 offen offset:512 sc1
v_cvt_pk_bf16_f32 v32, v112, v113
v_cvt_pk_bf16_f32 v33, v114, v115
v_cvt_pk_bf16_f32 v34, v120, v121
v_cvt_pk_bf16_f32 v35, v122, v123
v_cvt_pk_bf16_f32 v36, v116, v117
v_cvt_pk_bf16_f32 v37, v118, v119
v_cvt_pk_bf16_f32 v38, v124, v125
v_cvt_pk_bf16_f32 v39, v126, v127
s_add_u32 s29, s28, 266240
buffer_store_dwordx4 v[32:35], v2, s[4:7], s29 offen offset:0 sc1
buffer_store_dwordx4 v[36:39], v2, s[4:7], s29 offen offset:512 sc1
s_mov_b32 s30, 1024
s_branch WE_SIG
WE_F1:
v_and_b32 v2, 31, v0
s_lshr_b32 s28, s24, 1
s_lshl_b32 s28, s28, 6
v_add_u32 v2, s28, v2
v_mul_u32_u24 v2, 3456, v2
v_lshrrev_b32 v3, 5, v0
v_lshl_add_u32 v2, v3, 4, v2
s_and_b32 s28, s24, 1
s_lshl_b32 s28, s28, 6
v_add_u32 v2, s28, v2
s_mul_i32 s28, s56, 442368
s_lshl_b32 s29, s57, 7
s_add_u32 s28, s28, s29
s_add_u32 s28, s28, 54525952
v_mul_f32 v4, 0xbfb8aa3b, v64
v_exp_f32 v4, v4
s_nop 0
v_add_f32 v4, 1.0, v4
v_rcp_f32 v4, v4
s_nop 0
v_mul_f32 v64, v64, v4
v_mul_f32 v64, v64, v80
v_mul_f32 v5, 0xbfb8aa3b, v65
v_exp_f32 v5, v5
s_nop 0
v_add_f32 v5, 1.0, v5
v_rcp_f32 v5, v5
s_nop 0
v_mul_f32 v65, v65, v5
v_mul_f32 v65, v65, v81
v_mul_f32 v6, 0xbfb8aa3b, v66
v_exp_f32 v6, v6
s_nop 0
v_add_f32 v6, 1.0, v6
v_rcp_f32 v6, v6
s_nop 0
v_mul_f32 v66, v66, v6
v_mul_f32 v66, v66, v82
v_mul_f32 v7, 0xbfb8aa3b, v67
v_exp_f32 v7, v7
s_nop 0
v_add_f32 v7, 1.0, v7
v_rcp_f32 v7, v7
s_nop 0
v_mul_f32 v67, v67, v7
v_mul_f32 v67, v67, v83
v_mul_f32 v4, 0xbfb8aa3b, v68
v_exp_f32 v4, v4
s_nop 0
v_add_f32 v4, 1.0, v4
v_rcp_f32 v4, v4
s_nop 0
v_mul_f32 v68, v68, v4
v_mul_f32 v68, v68, v84
v_mul_f32 v5, 0xbfb8aa3b, v69
v_exp_f32 v5, v5
s_nop 0
v_add_f32 v5, 1.0, v5
v_rcp_f32 v5, v5
s_nop 0
v_mul_f32 v69, v69, v5
v_mul_f32 v69, v69, v85
v_mul_f32 v6, 0xbfb8aa3b, v70
v_exp_f32 v6, v6
s_nop 0
v_add_f32 v6, 1.0, v6
v_rcp_f32 v6, v6
s_nop 0
v_mul_f32 v70, v70, v6
v_mul_f32 v70, v70, v86
v_mul_f32 v7, 0xbfb8aa3b, v71
v_exp_f32 v7, v7
s_nop 0
v_add_f32 v7, 1.0, v7
v_rcp_f32 v7, v7
s_nop 0
v_mul_f32 v71, v71, v7
v_mul_f32 v71, v71, v87
v_mul_f32 v4, 0xbfb8aa3b, v72
v_exp_f32 v4, v4
s_nop 0
v_add_f32 v4, 1.0, v4
v_rcp_f32 v4, v4
s_nop 0
v_mul_f32 v72, v72, v4
v_mul_f32 v72, v72, v88
v_mul_f32 v5, 0xbfb8aa3b, v73
v_exp_f32 v5, v5
s_nop 0
v_add_f32 v5, 1.0, v5
v_rcp_f32 v5, v5
s_nop 0
v_mul_f32 v73, v73, v5
v_mul_f32 v73, v73, v89
v_mul_f32 v6, 0xbfb8aa3b, v74
v_exp_f32 v6, v6
s_nop 0
v_add_f32 v6, 1.0, v6
v_rcp_f32 v6, v6
s_nop 0
v_mul_f32 v74, v74, v6
v_mul_f32 v74, v74, v90
v_mul_f32 v7, 0xbfb8aa3b, v75
v_exp_f32 v7, v7
s_nop 0
v_add_f32 v7, 1.0, v7
v_rcp_f32 v7, v7
s_nop 0
v_mul_f32 v75, v75, v7
v_mul_f32 v75, v75, v91
v_mul_f32 v4, 0xbfb8aa3b, v76
v_exp_f32 v4, v4
s_nop 0
v_add_f32 v4, 1.0, v4
v_rcp_f32 v4, v4
s_nop 0
v_mul_f32 v76, v76, v4
v_mul_f32 v76, v76, v92
v_mul_f32 v5, 0xbfb8aa3b, v77
v_exp_f32 v5, v5
s_nop 0
v_add_f32 v5, 1.0, v5
v_rcp_f32 v5, v5
s_nop 0
v_mul_f32 v77, v77, v5
v_mul_f32 v77, v77, v93
v_mul_f32 v6, 0xbfb8aa3b, v78
v_exp_f32 v6, v6
s_nop 0
v_add_f32 v6, 1.0, v6
v_rcp_f32 v6, v6
s_nop 0
v_mul_f32 v78, v78, v6
v_mul_f32 v78, v78, v94
v_mul_f32 v7, 0xbfb8aa3b, v79
v_exp_f32 v7, v7
s_nop 0
v_add_f32 v7, 1.0, v7
v_rcp_f32 v7, v7
s_nop 0
v_mul_f32 v79, v79, v7
v_mul_f32 v79, v79, v95
v_cvt_pk_bf16_f32 v8, v64, v65
v_cvt_pk_bf16_f32 v9, v66, v67
v_cvt_pk_bf16_f32 v10, v68, v69
v_cvt_pk_bf16_f32 v11, v70, v71
v_cvt_pk_bf16_f32 v12, v72, v73
v_cvt_pk_bf16_f32 v13, v74, v75
v_cvt_pk_bf16_f32 v14, v76, v77
v_cvt_pk_bf16_f32 v15, v78, v79
v_permlane32_swap_b32 v8, v10
v_permlane32_swap_b32 v9, v11
v_permlane32_swap_b32 v12, v14
v_permlane32_swap_b32 v13, v15
s_add_u32 s29, s28, 0
buffer_store_dwordx4 v[8:11], v2, s[4:7], s29 offen offset:0 sc1
buffer_store_dwordx4 v[12:15], v2, s[4:7], s29 offen offset:32 sc1
v_mul_f32 v4, 0xbfb8aa3b, v96
v_exp_f32 v4, v4
s_nop 0
v_add_f32 v4, 1.0, v4
v_rcp_f32 v4, v4
s_nop 0
v_mul_f32 v96, v96, v4
v_mul_f32 v96, v96, v112
v_mul_f32 v5, 0xbfb8aa3b, v97
v_exp_f32 v5, v5
s_nop 0
v_add_f32 v5, 1.0, v5
v_rcp_f32 v5, v5
s_nop 0
v_mul_f32 v97, v97, v5
v_mul_f32 v97, v97, v113
v_mul_f32 v6, 0xbfb8aa3b, v98
v_exp_f32 v6, v6
s_nop 0
v_add_f32 v6, 1.0, v6
v_rcp_f32 v6, v6
s_nop 0
v_mul_f32 v98, v98, v6
v_mul_f32 v98, v98, v114
v_mul_f32 v7, 0xbfb8aa3b, v99
v_exp_f32 v7, v7
s_nop 0
v_add_f32 v7, 1.0, v7
v_rcp_f32 v7, v7
s_nop 0
v_mul_f32 v99, v99, v7
v_mul_f32 v99, v99, v115
v_mul_f32 v4, 0xbfb8aa3b, v100
v_exp_f32 v4, v4
s_nop 0
v_add_f32 v4, 1.0, v4
v_rcp_f32 v4, v4
s_nop 0
v_mul_f32 v100, v100, v4
v_mul_f32 v100, v100, v116
v_mul_f32 v5, 0xbfb8aa3b, v101
v_exp_f32 v5, v5
s_nop 0
v_add_f32 v5, 1.0, v5
v_rcp_f32 v5, v5
s_nop 0
v_mul_f32 v101, v101, v5
v_mul_f32 v101, v101, v117
v_mul_f32 v6, 0xbfb8aa3b, v102
v_exp_f32 v6, v6
s_nop 0
v_add_f32 v6, 1.0, v6
v_rcp_f32 v6, v6
s_nop 0
v_mul_f32 v102, v102, v6
v_mul_f32 v102, v102, v118
v_mul_f32 v7, 0xbfb8aa3b, v103
v_exp_f32 v7, v7
s_nop 0
v_add_f32 v7, 1.0, v7
v_rcp_f32 v7, v7
s_nop 0
v_mul_f32 v103, v103, v7
v_mul_f32 v103, v103, v119
v_mul_f32 v4, 0xbfb8aa3b, v104
v_exp_f32 v4, v4
s_nop 0
v_add_f32 v4, 1.0, v4
v_rcp_f32 v4, v4
s_nop 0
v_mul_f32 v104, v104, v4
v_mul_f32 v104, v104, v120
v_mul_f32 v5, 0xbfb8aa3b, v105
v_exp_f32 v5, v5
s_nop 0
v_add_f32 v5, 1.0, v5
v_rcp_f32 v5, v5
s_nop 0
v_mul_f32 v105, v105, v5
v_mul_f32 v105, v105, v121
v_mul_f32 v6, 0xbfb8aa3b, v106
v_exp_f32 v6, v6
s_nop 0
v_add_f32 v6, 1.0, v6
v_rcp_f32 v6, v6
s_nop 0
v_mul_f32 v106, v106, v6
v_mul_f32 v106, v106, v122
v_mul_f32 v7, 0xbfb8aa3b, v107
v_exp_f32 v7, v7
s_nop 0
v_add_f32 v7, 1.0, v7
v_rcp_f32 v7, v7
s_nop 0
v_mul_f32 v107, v107, v7
v_mul_f32 v107, v107, v123
v_mul_f32 v4, 0xbfb8aa3b, v108
v_exp_f32 v4, v4
s_nop 0
v_add_f32 v4, 1.0, v4
v_rcp_f32 v4, v4
s_nop 0
v_mul_f32 v108, v108, v4
v_mul_f32 v108, v108, v124
v_mul_f32 v5, 0xbfb8aa3b, v109
v_exp_f32 v5, v5
s_nop 0
v_add_f32 v5, 1.0, v5
v_rcp_f32 v5, v5
s_nop 0
v_mul_f32 v109, v109, v5
v_mul_f32 v109, v109, v125
v_mul_f32 v6, 0xbfb8aa3b, v110
v_exp_f32 v6, v6
s_nop 0
v_add_f32 v6, 1.0, v6
v_rcp_f32 v6, v6
s_nop 0
v_mul_f32 v110, v110, v6
v_mul_f32 v110, v110, v126
v_mul_f32 v7, 0xbfb8aa3b, v111
v_exp_f32 v7, v7
s_nop 0
v_add_f32 v7, 1.0, v7
v_rcp_f32 v7, v7
s_nop 0
v_mul_f32 v111, v111, v7
v_mul_f32 v111, v111, v127
v_cvt_pk_bf16_f32 v16, v96, v97
v_cvt_pk_bf16_f32 v17, v98, v99
v_cvt_pk_bf16_f32 v18, v100, v101
v_cvt_pk_bf16_f32 v19, v102, v103
v_cvt_pk_bf16_f32 v20, v104, v105
v_cvt_pk_bf16_f32 v21, v106, v107
v_cvt_pk_bf16_f32 v22, v108, v109
v_cvt_pk_bf16_f32 v23, v110, v111
v_permlane32_swap_b32 v16, v18
v_permlane32_swap_b32 v17, v19
v_permlane32_swap_b32 v20, v22
v_permlane32_swap_b32 v21, v23
s_add_u32 s29, s28, 110592
buffer_store_dwordx4 v[16:19], v2, s[4:7], s29 offen offset:0 sc1
buffer_store_dwordx4 v[20:23], v2, s[4:7], s29 offen offset:32 sc1
s_mov_b32 s30, 7168
s_branch WE_SIG
WE_F2:
v_and_b32 v2, 31, v0
s_lshr_b32 s28, s24, 1
s_lshl_b32 s28, s28, 6
v_add_u32 v2, s28, v2
v_mul_u32_u24 v2, 1280, v2
v_lshrrev_b32 v3, 5, v0
v_lshl_add_u32 v2, v3, 4, v2
s_and_b32 s28, s24, 1
s_lshl_b32 s28, s28, 6
v_add_u32 v2, s28, v2
s_mul_i32 s28, s56, 163840
s_lshl_b32 s29, s57, 8
s_add_u32 s28, s28, s29
s_add_u32 s28, s28, 61865984
v_mul_f32 v4, 0xbfb8aa3b, v64
v_exp_f32 v4, v4
s_nop 0
v_add_f32 v4, 1.0, v4
v_rcp_f32 v4, v4
s_nop 0
v_mul_f32 v64, v64, v4
v_mul_f32 v5, 0xbfb8aa3b, v65
v_exp_f32 v5, v5
s_nop 0
v_add_f32 v5, 1.0, v5
v_rcp_f32 v5, v5
s_nop 0
v_mul_f32 v65, v65, v5
v_mul_f32 v6, 0xbfb8aa3b, v66
v_exp_f32 v6, v6
s_nop 0
v_add_f32 v6, 1.0, v6
v_rcp_f32 v6, v6
s_nop 0
v_mul_f32 v66, v66, v6
v_mul_f32 v7, 0xbfb8aa3b, v67
v_exp_f32 v7, v7
s_nop 0
v_add_f32 v7, 1.0, v7
v_rcp_f32 v7, v7
s_nop 0
v_mul_f32 v67, v67, v7
v_mul_f32 v4, 0xbfb8aa3b, v68
v_exp_f32 v4, v4
s_nop 0
v_add_f32 v4, 1.0, v4
v_rcp_f32 v4, v4
s_nop 0
v_mul_f32 v68, v68, v4
v_mul_f32 v5, 0xbfb8aa3b, v69
v_exp_f32 v5, v5
s_nop 0
v_add_f32 v5, 1.0, v5
v_rcp_f32 v5, v5
s_nop 0
v_mul_f32 v69, v69, v5
v_mul_f32 v6, 0xbfb8aa3b, v70
v_exp_f32 v6, v6
s_nop 0
v_add_f32 v6, 1.0, v6
v_rcp_f32 v6, v6
s_nop 0
v_mul_f32 v70, v70, v6
v_mul_f32 v7, 0xbfb8aa3b, v71
v_exp_f32 v7, v7
s_nop 0
v_add_f32 v7, 1.0, v7
v_rcp_f32 v7, v7
s_nop 0
v_mul_f32 v71, v71, v7
v_mul_f32 v4, 0xbfb8aa3b, v72
v_exp_f32 v4, v4
s_nop 0
v_add_f32 v4, 1.0, v4
v_rcp_f32 v4, v4
s_nop 0
v_mul_f32 v72, v72, v4
v_mul_f32 v5, 0xbfb8aa3b, v73
v_exp_f32 v5, v5
s_nop 0
v_add_f32 v5, 1.0, v5
v_rcp_f32 v5, v5
s_nop 0
v_mul_f32 v73, v73, v5
v_mul_f32 v6, 0xbfb8aa3b, v74
v_exp_f32 v6, v6
s_nop 0
v_add_f32 v6, 1.0, v6
v_rcp_f32 v6, v6
s_nop 0
v_mul_f32 v74, v74, v6
v_mul_f32 v7, 0xbfb8aa3b, v75
v_exp_f32 v7, v7
s_nop 0
v_add_f32 v7, 1.0, v7
v_rcp_f32 v7, v7
s_nop 0
v_mul_f32 v75, v75, v7
v_mul_f32 v4, 0xbfb8aa3b, v76
v_exp_f32 v4, v4
s_nop 0
v_add_f32 v4, 1.0, v4
v_rcp_f32 v4, v4
s_nop 0
v_mul_f32 v76, v76, v4
v_mul_f32 v5, 0xbfb8aa3b, v77
v_exp_f32 v5, v5
s_nop 0
v_add_f32 v5, 1.0, v5
v_rcp_f32 v5, v5
s_nop 0
v_mul_f32 v77, v77, v5
v_mul_f32 v6, 0xbfb8aa3b, v78
v_exp_f32 v6, v6
s_nop 0
v_add_f32 v6, 1.0, v6
v_rcp_f32 v6, v6
s_nop 0
v_mul_f32 v78, v78, v6
v_mul_f32 v7, 0xbfb8aa3b, v79
v_exp_f32 v7, v7
s_nop 0
v_add_f32 v7, 1.0, v7
v_rcp_f32 v7, v7
s_nop 0
v_mul_f32 v79, v79, v7
v_cvt_pk_bf16_f32 v8, v64, v65
v_cvt_pk_bf16_f32 v9, v66, v67
v_cvt_pk_bf16_f32 v10, v68, v69
v_cvt_pk_bf16_f32 v11, v70, v71
v_cvt_pk_bf16_f32 v12, v72, v73
v_cvt_pk_bf16_f32 v13, v74, v75
v_cvt_pk_bf16_f32 v14, v76, v77
v_cvt_pk_bf16_f32 v15, v78, v79
v_permlane32_swap_b32 v8, v10
v_permlane32_swap_b32 v9, v11
v_permlane32_swap_b32 v12, v14
v_permlane32_swap_b32 v13, v15
s_add_u32 s29, s28, 0
buffer_store_dwordx4 v[8:11], v2, s[4:7], s29 offen offset:0 sc1
buffer_store_dwordx4 v[12:15], v2, s[4:7], s29 offen offset:32 sc1
v_mul_f32 v4, 0xbfb8aa3b, v80
v_exp_f32 v4, v4
s_nop 0
v_add_f32 v4, 1.0, v4
v_rcp_f32 v4, v4
s_nop 0
v_mul_f32 v80, v80, v4
v_mul_f32 v5, 0xbfb8aa3b, v81
v_exp_f32 v5, v5
s_nop 0
v_add_f32 v5, 1.0, v5
v_rcp_f32 v5, v5
s_nop 0
v_mul_f32 v81, v81, v5
v_mul_f32 v6, 0xbfb8aa3b, v82
v_exp_f32 v6, v6
s_nop 0
v_add_f32 v6, 1.0, v6
v_rcp_f32 v6, v6
s_nop 0
v_mul_f32 v82, v82, v6
v_mul_f32 v7, 0xbfb8aa3b, v83
v_exp_f32 v7, v7
s_nop 0
v_add_f32 v7, 1.0, v7
v_rcp_f32 v7, v7
s_nop 0
v_mul_f32 v83, v83, v7
v_mul_f32 v4, 0xbfb8aa3b, v84
v_exp_f32 v4, v4
s_nop 0
v_add_f32 v4, 1.0, v4
v_rcp_f32 v4, v4
s_nop 0
v_mul_f32 v84, v84, v4
v_mul_f32 v5, 0xbfb8aa3b, v85
v_exp_f32 v5, v5
s_nop 0
v_add_f32 v5, 1.0, v5
v_rcp_f32 v5, v5
s_nop 0
v_mul_f32 v85, v85, v5
v_mul_f32 v6, 0xbfb8aa3b, v86
v_exp_f32 v6, v6
s_nop 0
v_add_f32 v6, 1.0, v6
v_rcp_f32 v6, v6
s_nop 0
v_mul_f32 v86, v86, v6
v_mul_f32 v7, 0xbfb8aa3b, v87
v_exp_f32 v7, v7
s_nop 0
v_add_f32 v7, 1.0, v7
v_rcp_f32 v7, v7
s_nop 0
v_mul_f32 v87, v87, v7
v_mul_f32 v4, 0xbfb8aa3b, v88
v_exp_f32 v4, v4
s_nop 0
v_add_f32 v4, 1.0, v4
v_rcp_f32 v4, v4
s_nop 0
v_mul_f32 v88, v88, v4
v_mul_f32 v5, 0xbfb8aa3b, v89
v_exp_f32 v5, v5
s_nop 0
v_add_f32 v5, 1.0, v5
v_rcp_f32 v5, v5
s_nop 0
v_mul_f32 v89, v89, v5
v_mul_f32 v6, 0xbfb8aa3b, v90
v_exp_f32 v6, v6
s_nop 0
v_add_f32 v6, 1.0, v6
v_rcp_f32 v6, v6
s_nop 0
v_mul_f32 v90, v90, v6
v_mul_f32 v7, 0xbfb8aa3b, v91
v_exp_f32 v7, v7
s_nop 0
v_add_f32 v7, 1.0, v7
v_rcp_f32 v7, v7
s_nop 0
v_mul_f32 v91, v91, v7
v_mul_f32 v4, 0xbfb8aa3b, v92
v_exp_f32 v4, v4
s_nop 0
v_add_f32 v4, 1.0, v4
v_rcp_f32 v4, v4
s_nop 0
v_mul_f32 v92, v92, v4
v_mul_f32 v5, 0xbfb8aa3b, v93
v_exp_f32 v5, v5
s_nop 0
v_add_f32 v5, 1.0, v5
v_rcp_f32 v5, v5
s_nop 0
v_mul_f32 v93, v93, v5
v_mul_f32 v6, 0xbfb8aa3b, v94
v_exp_f32 v6, v6
s_nop 0
v_add_f32 v6, 1.0, v6
v_rcp_f32 v6, v6
s_nop 0
v_mul_f32 v94, v94, v6
v_mul_f32 v7, 0xbfb8aa3b, v95
v_exp_f32 v7, v7
s_nop 0
v_add_f32 v7, 1.0, v7
v_rcp_f32 v7, v7
s_nop 0
v_mul_f32 v95, v95, v7
v_cvt_pk_bf16_f32 v16, v80, v81
v_cvt_pk_bf16_f32 v17, v82, v83
v_cvt_pk_bf16_f32 v18, v84, v85
v_cvt_pk_bf16_f32 v19, v86, v87
v_cvt_pk_bf16_f32 v20, v88, v89
v_cvt_pk_bf16_f32 v21, v90, v91
v_cvt_pk_bf16_f32 v22, v92, v93
v_cvt_pk_bf16_f32 v23, v94, v95
v_permlane32_swap_b32 v16, v18
v_permlane32_swap_b32 v17, v19
v_permlane32_swap_b32 v20, v22
v_permlane32_swap_b32 v21, v23
s_add_u32 s29, s28, 128
buffer_store_dwordx4 v[16:19], v2, s[4:7], s29 offen offset:0 sc1
buffer_store_dwordx4 v[20:23], v2, s[4:7], s29 offen offset:32 sc1
v_mul_f32 v4, 0xbfb8aa3b, v96
v_exp_f32 v4, v4
s_nop 0
v_add_f32 v4, 1.0, v4
v_rcp_f32 v4, v4
s_nop 0
v_mul_f32 v96, v96, v4
v_mul_f32 v5, 0xbfb8aa3b, v97
v_exp_f32 v5, v5
s_nop 0
v_add_f32 v5, 1.0, v5
v_rcp_f32 v5, v5
s_nop 0
v_mul_f32 v97, v97, v5
v_mul_f32 v6, 0xbfb8aa3b, v98
v_exp_f32 v6, v6
s_nop 0
v_add_f32 v6, 1.0, v6
v_rcp_f32 v6, v6
s_nop 0
v_mul_f32 v98, v98, v6
v_mul_f32 v7, 0xbfb8aa3b, v99
v_exp_f32 v7, v7
s_nop 0
v_add_f32 v7, 1.0, v7
v_rcp_f32 v7, v7
s_nop 0
v_mul_f32 v99, v99, v7
v_mul_f32 v4, 0xbfb8aa3b, v100
v_exp_f32 v4, v4
s_nop 0
v_add_f32 v4, 1.0, v4
v_rcp_f32 v4, v4
s_nop 0
v_mul_f32 v100, v100, v4
v_mul_f32 v5, 0xbfb8aa3b, v101
v_exp_f32 v5, v5
s_nop 0
v_add_f32 v5, 1.0, v5
v_rcp_f32 v5, v5
s_nop 0
v_mul_f32 v101, v101, v5
v_mul_f32 v6, 0xbfb8aa3b, v102
v_exp_f32 v6, v6
s_nop 0
v_add_f32 v6, 1.0, v6
v_rcp_f32 v6, v6
s_nop 0
v_mul_f32 v102, v102, v6
v_mul_f32 v7, 0xbfb8aa3b, v103
v_exp_f32 v7, v7
s_nop 0
v_add_f32 v7, 1.0, v7
v_rcp_f32 v7, v7
s_nop 0
v_mul_f32 v103, v103, v7
v_mul_f32 v4, 0xbfb8aa3b, v104
v_exp_f32 v4, v4
s_nop 0
v_add_f32 v4, 1.0, v4
v_rcp_f32 v4, v4
s_nop 0
v_mul_f32 v104, v104, v4
v_mul_f32 v5, 0xbfb8aa3b, v105
v_exp_f32 v5, v5
s_nop 0
v_add_f32 v5, 1.0, v5
v_rcp_f32 v5, v5
s_nop 0
v_mul_f32 v105, v105, v5
v_mul_f32 v6, 0xbfb8aa3b, v106
v_exp_f32 v6, v6
s_nop 0
v_add_f32 v6, 1.0, v6
v_rcp_f32 v6, v6
s_nop 0
v_mul_f32 v106, v106, v6
v_mul_f32 v7, 0xbfb8aa3b, v107
v_exp_f32 v7, v7
s_nop 0
v_add_f32 v7, 1.0, v7
v_rcp_f32 v7, v7
s_nop 0
v_mul_f32 v107, v107, v7
v_mul_f32 v4, 0xbfb8aa3b, v108
v_exp_f32 v4, v4
s_nop 0
v_add_f32 v4, 1.0, v4
v_rcp_f32 v4, v4
s_nop 0
v_mul_f32 v108, v108, v4
v_mul_f32 v5, 0xbfb8aa3b, v109
v_exp_f32 v5, v5
s_nop 0
v_add_f32 v5, 1.0, v5
v_rcp_f32 v5, v5
s_nop 0
v_mul_f32 v109, v109, v5
v_mul_f32 v6, 0xbfb8aa3b, v110
v_exp_f32 v6, v6
s_nop 0
v_add_f32 v6, 1.0, v6
v_rcp_f32 v6, v6
s_nop 0
v_mul_f32 v110, v110, v6
v_mul_f32 v7, 0xbfb8aa3b, v111
v_exp_f32 v7, v7
s_nop 0
v_add_f32 v7, 1.0, v7
v_rcp_f32 v7, v7
s_nop 0
v_mul_f32 v111, v111, v7
v_cvt_pk_bf16_f32 v24, v96, v97
v_cvt_pk_bf16_f32 v25, v98, v99
v_cvt_pk_bf16_f32 v26, v100, v101
v_cvt_pk_bf16_f32 v27, v102, v103
v_cvt_pk_bf16_f32 v28, v104, v105
v_cvt_pk_bf16_f32 v29, v106, v107
v_cvt_pk_bf16_f32 v30, v108, v109
v_cvt_pk_bf16_f32 v31, v110, v111
v_permlane32_swap_b32 v24, v26
v_permlane32_swap_b32 v25, v27
v_permlane32_swap_b32 v28, v30
v_permlane32_swap_b32 v29, v31
s_add_u32 s29, s28, 40960
buffer_store_dwordx4 v[24:27], v2, s[4:7], s29 offen offset:0 sc1
buffer_store_dwordx4 v[28:31], v2, s[4:7], s29 offen offset:32 sc1
v_mul_f32 v4, 0xbfb8aa3b, v112
v_exp_f32 v4, v4
s_nop 0
v_add_f32 v4, 1.0, v4
v_rcp_f32 v4, v4
s_nop 0
v_mul_f32 v112, v112, v4
v_mul_f32 v5, 0xbfb8aa3b, v113
v_exp_f32 v5, v5
s_nop 0
v_add_f32 v5, 1.0, v5
v_rcp_f32 v5, v5
s_nop 0
v_mul_f32 v113, v113, v5
v_mul_f32 v6, 0xbfb8aa3b, v114
v_exp_f32 v6, v6
s_nop 0
v_add_f32 v6, 1.0, v6
v_rcp_f32 v6, v6
s_nop 0
v_mul_f32 v114, v114, v6
v_mul_f32 v7, 0xbfb8aa3b, v115
v_exp_f32 v7, v7
s_nop 0
v_add_f32 v7, 1.0, v7
v_rcp_f32 v7, v7
s_nop 0
v_mul_f32 v115, v115, v7
v_mul_f32 v4, 0xbfb8aa3b, v116
v_exp_f32 v4, v4
s_nop 0
v_add_f32 v4, 1.0, v4
v_rcp_f32 v4, v4
s_nop 0
v_mul_f32 v116, v116, v4
v_mul_f32 v5, 0xbfb8aa3b, v117
v_exp_f32 v5, v5
s_nop 0
v_add_f32 v5, 1.0, v5
v_rcp_f32 v5, v5
s_nop 0
v_mul_f32 v117, v117, v5
v_mul_f32 v6, 0xbfb8aa3b, v118
v_exp_f32 v6, v6
s_nop 0
v_add_f32 v6, 1.0, v6
v_rcp_f32 v6, v6
s_nop 0
v_mul_f32 v118, v118, v6
v_mul_f32 v7, 0xbfb8aa3b, v119
v_exp_f32 v7, v7
s_nop 0
v_add_f32 v7, 1.0, v7
v_rcp_f32 v7, v7
s_nop 0
v_mul_f32 v119, v119, v7
v_mul_f32 v4, 0xbfb8aa3b, v120
v_exp_f32 v4, v4
s_nop 0
v_add_f32 v4, 1.0, v4
v_rcp_f32 v4, v4
s_nop 0
v_mul_f32 v120, v120, v4
v_mul_f32 v5, 0xbfb8aa3b, v121
v_exp_f32 v5, v5
s_nop 0
v_add_f32 v5, 1.0, v5
v_rcp_f32 v5, v5
s_nop 0
v_mul_f32 v121, v121, v5
v_mul_f32 v6, 0xbfb8aa3b, v122
v_exp_f32 v6, v6
s_nop 0
v_add_f32 v6, 1.0, v6
v_rcp_f32 v6, v6
s_nop 0
v_mul_f32 v122, v122, v6
v_mul_f32 v7, 0xbfb8aa3b, v123
v_exp_f32 v7, v7
s_nop 0
v_add_f32 v7, 1.0, v7
v_rcp_f32 v7, v7
s_nop 0
v_mul_f32 v123, v123, v7
v_mul_f32 v4, 0xbfb8aa3b, v124
v_exp_f32 v4, v4
s_nop 0
v_add_f32 v4, 1.0, v4
v_rcp_f32 v4, v4
s_nop 0
v_mul_f32 v124, v124, v4
v_mul_f32 v5, 0xbfb8aa3b, v125
v_exp_f32 v5, v5
s_nop 0
v_add_f32 v5, 1.0, v5
v_rcp_f32 v5, v5
s_nop 0
v_mul_f32 v125, v125, v5
v_mul_f32 v6, 0xbfb8aa3b, v126
v_exp_f32 v6, v6
s_nop 0
v_add_f32 v6, 1.0, v6
v_rcp_f32 v6, v6
s_nop 0
v_mul_f32 v126, v126, v6
v_mul_f32 v7, 0xbfb8aa3b, v127
v_exp_f32 v7, v7
s_nop 0
v_add_f32 v7, 1.0, v7
v_rcp_f32 v7, v7
s_nop 0
v_mul_f32 v127, v127, v7
v_cvt_pk_bf16_f32 v32, v112, v113
v_cvt_pk_bf16_f32 v33, v114, v115
v_cvt_pk_bf16_f32 v34, v116, v117
v_cvt_pk_bf16_f32 v35, v118, v119
v_cvt_pk_bf16_f32 v36, v120, v121
v_cvt_pk_bf16_f32 v37, v122, v123
v_cvt_pk_bf16_f32 v38, v124, v125
v_cvt_pk_bf16_f32 v39, v126, v127
v_permlane32_swap_b32 v32, v34
v_permlane32_swap_b32 v33, v35
v_permlane32_swap_b32 v36, v38
v_permlane32_swap_b32 v37, v39
s_add_u32 s29, s28, 41088
buffer_store_dwordx4 v[32:35], v2, s[4:7], s29 offen offset:0 sc1
buffer_store_dwordx4 v[36:39], v2, s[4:7], s29 offen offset:32 sc1
s_mov_b32 s30, 9216
WE_SIG:
s_cmp_lt_u32 s55, 2
s_cselect_b32 s29, 8, 7
s_lshl_b32 s29, s56, s29
s_add_u32 s30, s30, s29
s_cmp_eq_u32 s55, 1
s_cselect_b32 s29, 32, 0
s_add_u32 s29, s29, s57
s_lshl_b32 s29, s29, 2
s_add_u32 s30, s30, s29
s_waitcnt vmcnt(0)
s_barrier
s_cmp_lg_u32 s24, 0
s_cbranch_scc1 SG_44
v_mov_b32 v3, 0
v_mov_b32 v2, 1
s_mov_b64 exec, 1
buffer_store_dword v2, v3, s[4:7], s30 offen sc1
s_mov_b64 exec, -1
SG_44:
s_add_u32 s61, s61, 1
s_branch WTASK
WBATCH_END:
s_cmp_lt_u32 s25, 64
s_cbranch_scc1 ATT
s_cmp_lt_u32 s25, 184
s_cbranch_scc1 WO
s_endpgm
ATT:
s_lshr_b32 s50, s25, 3
s_and_b32 s51, s25, 7
s_lshl_b32 s51, s51, 2
s_add_u32 s51, s51, s24
v_lshlrev_b32 v1, 4, v0
v_and_b32 v2, 15, v0
v_lshrrev_b32 v3, 4, v0
v_lshlrev_b32 v3, 2, v3
s_mov_b32 s56, 0x3e0293ee
v_mov_b32 v148, 0xd028965f
s_lshl_b32 s28, s24, 12
v_lshlrev_b32 v4, 5, v2
v_lshl_add_u32 v4, v3, 1, v4
v_add_u32 v154, s28, v4
v_bfe_u32 v4, v0, 2, 2
v_lshl_add_u32 v4, v3, 1, v4
v_lshlrev_b32 v4, 5, v4
v_and_b32 v5, 3, v0
v_lshl_add_u32 v4, v5, 3, v4
v_add_u32 v155, s28, v4
v_add_u32 v4, 0, v3
v_cmp_le_u32 s[70:71], v4, v2
v_add_u32 v4, 1, v3
v_cmp_le_u32 s[72:73], v4, v2
v_add_u32 v4, 2, v3
v_cmp_le_u32 s[74:75], v4, v2
v_add_u32 v4, 3, v3
v_cmp_le_u32 s[76:77], v4, v2
ATL:
s_lshr_b32 s52, s50, 2
s_lshl_b32 s52, s52, 7
s_add_u32 s53, s52, 5120
s_lshl_b32 s52, s52, 1
s_add_u32 s52, s52, 1024
v_mbcnt_lo_u32_b32 v3, -1, 0
v_mbcnt_hi_u32_b32 v3, -1, v3
v_min_u32 v3, 31, v3
v_lshlrev_b32 v3, 2, v3
s_mov_b32 s28, 0
PL_45:
buffer_load_dword v2, v3, s[4:7], s53 offen sc1
s_waitcnt vmcnt(0)
v_cmp_eq_u32 vcc, 0, v2
s_cbranch_vccz PD_46
s_add_u32 s28, s28, 1
s_cmp_lt_u32 s28, 131072
s_cbranch_scc1 PL_45
v_mov_b32 v2, 20
v_mov_b32 v3, 200864
buffer_store_dword v2, v3, s[4:7], 0 offen sc1
s_waitcnt vmcnt(0)
s_endpgm
PD_46:
v_mbcnt_lo_u32_b32 v3, -1, 0
v_mbcnt_hi_u32_b32 v3, -1, v3
v_lshlrev_b32 v3, 2, v3
s_mov_b32 s28, 0
PL_47:
buffer_load_dword v2, v3, s[4:7], s52 offen sc1
s_waitcnt vmcnt(0)
v_cmp_eq_u32 vcc, 0, v2
s_cbranch_vccz PD_48
s_add_u32 s28, s28, 1
s_cmp_lt_u32 s28, 131072
s_cbranch_scc1 PL_47
v_mov_b32 v2, 21
v_mov_b32 v3, 200864
buffer_store_dword v2, v3, s[4:7], 0 offen sc1
s_waitcnt vmcnt(0)
s_endpgm
PD_48:
s_lshl_b32 s55, s50, 5
s_add_u32 s55, s55, s51
s_lshl_b32 s54, s55, 13
s_add_u32 s52, s54, 37748736
s_add_u32 s53, s52, 4096
buffer_load_dwordx4 v[8:11], v1, s[4:7], s52 offen offset:0 sc1
buffer_load_dwordx4 v[12:15], v1, s[4:7], s52 offen offset:1024 sc1
buffer_load_dwordx4 v[16:19], v1, s[4:7], s52 offen offset:2048 sc1
buffer_load_dwordx4 v[20:23], v1, s[4:7], s52 offen offset:3072 sc1
buffer_load_dwordx4 v[24:27], v1, s[4:7], s53 offen offset:0 sc1
buffer_load_dwordx4 v[28:31], v1, s[4:7], s53 offen offset:1024 sc1
buffer_load_dwordx4 v[32:35], v1, s[4:7], s53 offen offset:2048 sc1
buffer_load_dwordx4 v[36:39], v1, s[4:7], s53 offen offset:3072 sc1
s_add_u32 s52, s54, 4194304
s_add_u32 s53, s52, 4096
buffer_load_dwordx4 v[40:43], v1, s[4:7], s52 offen offset:0 sc1
buffer_load_dwordx4 v[44:47], v1, s[4:7], s52 offen offset:1024 sc1
buffer_load_dwordx4 v[48:51], v1, s[4:7], s52 offen offset:2048 sc1
buffer_load_dwordx4 v[52:55], v1, s[4:7], s52 offen offset:3072 sc1
buffer_load_dwordx4 v[56:59], v1, s[4:7], s53 offen offset:0 sc1
buffer_load_dwordx4 v[60:63], v1, s[4:7], s53 offen offset:1024 sc1
buffer_load_dwordx4 v[64:67], v1, s[4:7], s53 offen offset:2048 sc1
buffer_load_dwordx4 v[68:71], v1, s[4:7], s53 offen offset:3072 sc1
s_add_u32 s52, s54, 20971520
s_add_u32 s53, s52, 4096
buffer_load_dwordx4 v[72:75], v1, s[4:7], s52 offen offset:0 sc1
buffer_load_dwordx4 v[76:79], v1, s[4:7], s52 offen offset:1024 sc1
buffer_load_dwordx4 v[80:83], v1, s[4:7], s52 offen offset:2048 sc1
buffer_load_dwordx4 v[84:87], v1, s[4:7], s52 offen offset:3072 sc1
buffer_load_dwordx4 v[88:91], v1, s[4:7], s53 offen offset:0 sc1
buffer_load_dwordx4 v[92:95], v1, s[4:7], s53 offen offset:1024 sc1
buffer_load_dwordx4 v[96:99], v1, s[4:7], s53 offen offset:2048 sc1
buffer_load_dwordx4 v[100:103], v1, s[4:7], s53 offen offset:3072 sc1
s_waitcnt vmcnt(8)
v_mfma_f32_16x16x32_bf16 v[128:131], v[40:43], v[8:11], 0
v_mfma_f32_16x16x32_bf16 v[132:135], v[40:43], v[12:15], 0
v_mfma_f32_16x16x32_bf16 v[136:139], v[44:47], v[12:15], 0
v_mfma_f32_16x16x32_bf16 v[128:131], v[48:51], v[16:19], v[128:131]
v_mfma_f32_16x16x32_bf16 v[132:135], v[48:51], v[20:23], v[132:135]
v_mfma_f32_16x16x32_bf16 v[136:139], v[52:55], v[20:23], v[136:139]
v_mfma_f32_16x16x32_bf16 v[128:131], v[56:59], v[24:27], v[128:131]
v_mfma_f32_16x16x32_bf16 v[132:135], v[56:59], v[28:31], v[132:135]
v_mfma_f32_16x16x32_bf16 v[136:139], v[60:63], v[28:31], v[136:139]
v_mfma_f32_16x16x32_bf16 v[128:131], v[64:67], v[32:35], v[128:131]
v_mfma_f32_16x16x32_bf16 v[132:135], v[64:67], v[36:39], v[132:135]
v_mfma_f32_16x16x32_bf16 v[136:139], v[68:71], v[36:39], v[136:139]
s_lshl_b32 s58, s55, 5
s_add_u32 s58, s58, 32768
s_cmp_eq_u32 s50, 63
s_cselect_b32 s57, 1024, 0
s_sub_u32 s58, s58, s57
v_and_b32 v2, 7, v0
v_lshlrev_b32 v2, 2, v2
s_mov_b32 s57, 0
AF_49:
buffer_load_dword v3, v2, s[4:7], s58 offen sc1
s_waitcnt vmcnt(0)
v_cmp_eq_u32 vcc, 0, v3
s_cbranch_vccz AD_50
s_add_u32 s57, s57, 1
s_cmp_lt_u32 s57, 131072
s_cbranch_scc1 AF_49
v_mov_b32 v2, 22
v_mov_b32 v3, 200864
buffer_store_dword v2, v3, s[4:7], 0 offen sc1
s_waitcnt vmcnt(0)
s_endpgm
AD_50:
s_lshl_b32 s52, s55, 12
s_add_u32 s52, s52, 65011712
s_lshl_b32 s53, s55, 11
s_add_u32 s53, s53, 73400320
v_lshlrev_b32 v2, 3, v0
s_mov_b32 s57, 0
AR_51:
buffer_load_dwordx4 v[160:163], v1, s[4:7], s52 offen offset:0 sc1
buffer_load_dwordx4 v[164:167], v1, s[4:7], s52 offen offset:1024 sc1
buffer_load_dwordx4 v[168:171], v1, s[4:7], s52 offen offset:2048 sc1
buffer_load_dwordx4 v[172:175], v1, s[4:7], s52 offen offset:3072 sc1
buffer_load_dwordx2 v[120:121], v2, s[4:7], s53 offen offset:0 sc1
buffer_load_dwordx2 v[122:123], v2, s[4:7], s53 offen offset:512 sc1
buffer_load_dwordx2 v[124:125], v2, s[4:7], s53 offen offset:1024 sc1
buffer_load_dwordx2 v[126:127], v2, s[4:7], s53 offen offset:1536 sc1
s_cmp_lg_u32 s50, 63
s_cbranch_scc1 AG_52
s_waitcnt vmcnt(0)
v_max3_u32 v3, v160, v161, v162
v_max3_u32 v3, v3, v163, v164
v_max3_u32 v3, v3, v165, v166
v_max3_u32 v3, v3, v167, v168
v_max3_u32 v3, v3, v169, v170
v_max3_u32 v3, v3, v171, v172
v_max3_u32 v3, v3, v173, v174
v_max_u32 v3, v3, v175
v_cmp_eq_u32 vcc, -1, v3
s_cbranch_vccz AG_52
s_add_u32 s57, s57, 1
s_cmp_lt_u32 s57, 131072
s_cbranch_scc1 AR_51
v_mov_b32 v2, 25
v_mov_b32 v3, 200864
buffer_store_dword v2, v3, s[4:7], 0 offen sc1
s_waitcnt vmcnt(0)
s_endpgm
AG_52:
v_cndmask_b32 v128, v148, v128, s[70:71]
v_cndmask_b32 v136, v148, v136, s[70:71]
v_cndmask_b32 v129, v148, v129, s[72:73]
v_cndmask_b32 v137, v148, v137, s[72:73]
v_cndmask_b32 v130, v148, v130, s[74:75]
v_cndmask_b32 v138, v148, v138, s[74:75]
v_cndmask_b32 v131, v148, v131, s[76:77]
v_cndmask_b32 v139, v148, v139, s[76:77]
s_waitcnt vmcnt(7)
ds_write_b64 v154, v[160:161] offset:0
ds_write_b64 v154, v[162:163] offset:2048
s_waitcnt vmcnt(6)
ds_write_b64 v154, v[164:165] offset:512
ds_write_b64 v154, v[166:167] offset:2560
s_waitcnt vmcnt(5)
ds_write_b64 v154, v[168:169] offset:1024
ds_write_b64 v154, v[170:171] offset:3072
s_waitcnt vmcnt(4)
ds_write_b64 v154, v[172:173] offset:1536
ds_write_b64 v154, v[174:175] offset:3584
s_waitcnt lgkmcnt(0)
ds_read_b64_tr_b16 v[104:105], v155 offset:0
ds_read_b64_tr_b16 v[106:107], v155 offset:128
ds_read_b64_tr_b16 v[108:109], v155 offset:1024
ds_read_b64_tr_b16 v[110:111], v155 offset:1152
ds_read_b64_tr_b16 v[112:113], v155 offset:2048
ds_read_b64_tr_b16 v[114:115], v155 offset:2176
ds_read_b64_tr_b16 v[116:117], v155 offset:3072
ds_read_b64_tr_b16 v[118:119], v155 offset:3200
s_waitcnt lgkmcnt(6)
v_mfma_f32_16x16x32_bf16 v[140:143], v[104:107], v[8:11], 0
v_mfma_f32_16x16x32_bf16 v[144:147], v[104:107], v[12:15], 0
s_waitcnt lgkmcnt(4)
v_mfma_f32_16x16x32_bf16 v[140:143], v[108:111], v[16:19], v[140:143]
v_mfma_f32_16x16x32_bf16 v[144:147], v[108:111], v[20:23], v[144:147]
s_waitcnt lgkmcnt(2)
v_mfma_f32_16x16x32_bf16 v[140:143], v[112:115], v[24:27], v[140:143]
v_mfma_f32_16x16x32_bf16 v[144:147], v[112:115], v[28:31], v[144:147]
s_waitcnt lgkmcnt(0)
v_mfma_f32_16x16x32_bf16 v[140:143], v[116:119], v[32:35], v[140:143]
v_mfma_f32_16x16x32_bf16 v[144:147], v[116:119], v[36:39], v[144:147]
v_max3_f32 v150, v128, v129, v130
v_max3_f32 v151, v132, v133, v134
v_max3_f32 v152, v135, v136, v137
v_max3_f32 v151, v151, v138, v139
v_max_f32 v150, v150, v131
v_max_f32 v151, v151, v152
v_max3_f32 v150, v150, v142, v143
s_nop 0
v_max3_f32 v151, v151, v146, v147
v_mov_b32 v152, v150
s_nop 1
v_permlane16_swap_b32 v150, v152
v_max_f32 v150, v150, v152
v_mov_b32 v152, v150
s_nop 1
v_permlane32_swap_b32 v150, v152
v_max_f32 v150, v150, v152
v_mov_b32 v153, v151
s_nop 1
v_permlane16_swap_b32 v151, v153
v_max_f32 v151, v151, v153
v_mov_b32 v153, v151
s_nop 1
v_permlane32_swap_b32 v151, v153
v_max_f32 v151, v151, v153
v_mul_f32 v150, s56, v150
v_mul_f32 v151, s56, v151
v_fma_f32 v128, v128, s56, -v150
v_fma_f32 v129, v129, s56, -v150
v_fma_f32 v130, v130, s56, -v150
v_fma_f32 v131, v131, s56, -v150
v_fma_f32 v142, v142, s56, -v150
v_fma_f32 v143, v143, s56, -v150
v_fma_f32 v132, v132, s56, -v151
v_fma_f32 v133, v133, s56, -v151
v_fma_f32 v134, v134, s56, -v151
v_fma_f32 v135, v135, s56, -v151
v_fma_f32 v136, v136, s56, -v151
v_fma_f32 v137, v137, s56, -v151
v_fma_f32 v138, v138, s56, -v151
v_fma_f32 v139, v139, s56, -v151
v_fma_f32 v146, v146, s56, -v151
v_fma_f32 v147, v147, s56, -v151
v_exp_f32 v128, v128
v_exp_f32 v129, v129
v_exp_f32 v130, v130
v_exp_f32 v131, v131
v_exp_f32 v142, v142
v_exp_f32 v143, v143
v_exp_f32 v132, v132
v_exp_f32 v133, v133
v_exp_f32 v134, v134
v_exp_f32 v135, v135
v_exp_f32 v136, v136
v_exp_f32 v137, v137
v_exp_f32 v138, v138
v_exp_f32 v139, v139
v_exp_f32 v146, v146
v_exp_f32 v147, v147
v_add_f32 v150, v128, v129
v_add_f32 v150, v150, v130
v_add_f32 v150, v150, v131
v_add_f32 v150, v150, v142
v_add_f32 v150, v150, v143
v_add_f32 v151, v132, v133
v_add_f32 v151, v151, v134
v_add_f32 v151, v151, v135
v_add_f32 v151, v151, v136
v_add_f32 v151, v151, v137
v_add_f32 v151, v151, v138
v_add_f32 v151, v151, v139
v_add_f32 v151, v151, v146
v_add_f32 v151, v151, v147
v_cvt_pk_bf16_f32 v224, v128, v129
v_cvt_pk_bf16_f32 v225, v130, v131
v_mov_b32 v226, 0
v_mov_b32 v227, 0
v_cvt_pk_bf16_f32 v228, v132, v133
v_cvt_pk_bf16_f32 v229, v134, v135
v_cvt_pk_bf16_f32 v230, v136, v137
v_cvt_pk_bf16_f32 v231, v138, v139
v_cvt_pk_bf16_f32 v232, v142, v143
v_mov_b32 v233, 0
v_mov_b32 v234, 0
v_mov_b32 v235, v232
v_cvt_pk_bf16_f32 v236, v146, v147
v_mov_b32 v237, 0
v_mov_b32 v238, 0
v_mov_b32 v239, v236
v_mfma_f32_16x16x32_bf16 v[160:163], v[72:75], v[224:227], 0
v_mfma_f32_16x16x32_bf16 v[164:167], v[72:75], v[228:231], 0
v_mfma_f32_16x16x32_bf16 v[168:171], v[76:79], v[224:227], 0
v_mfma_f32_16x16x32_bf16 v[172:175], v[76:79], v[228:231], 0
v_mfma_f32_16x16x32_bf16 v[176:179], v[80:83], v[224:227], 0
v_mfma_f32_16x16x32_bf16 v[180:183], v[80:83], v[228:231], 0
v_mfma_f32_16x16x32_bf16 v[184:187], v[84:87], v[224:227], 0
v_mfma_f32_16x16x32_bf16 v[188:191], v[84:87], v[228:231], 0
v_mfma_f32_16x16x32_bf16 v[192:195], v[88:91], v[224:227], 0
v_mfma_f32_16x16x32_bf16 v[196:199], v[88:91], v[228:231], 0
v_mfma_f32_16x16x32_bf16 v[200:203], v[92:95], v[224:227], 0
v_mfma_f32_16x16x32_bf16 v[204:207], v[92:95], v[228:231], 0
v_mfma_f32_16x16x32_bf16 v[208:211], v[96:99], v[224:227], 0
v_mfma_f32_16x16x32_bf16 v[212:215], v[96:99], v[228:231], 0
v_mfma_f32_16x16x32_bf16 v[216:219], v[100:103], v[224:227], 0
v_mfma_f32_16x16x32_bf16 v[220:223], v[100:103], v[228:231], 0
v_mov_b32 v152, v150
s_nop 1
v_permlane16_swap_b32 v150, v152
v_add_f32 v150, v150, v152
v_mov_b32 v152, v150
s_nop 1
v_permlane32_swap_b32 v150, v152
v_add_f32 v150, v150, v152
v_mov_b32 v153, v151
s_nop 1
v_permlane16_swap_b32 v151, v153
v_add_f32 v151, v151, v153
v_mov_b32 v153, v151
s_nop 1
v_permlane32_swap_b32 v151, v153
v_add_f32 v151, v151, v153
v_rcp_f32 v150, v150
v_rcp_f32 v151, v151
s_waitcnt vmcnt(0)
s_cmp_lg_u32 s50, 63
s_cbranch_scc1 VG_54
s_mov_b32 s57, 0
VL_53:
v_max3_u32 v3, v120, v121, v122
v_max3_u32 v3, v3, v123, v124
v_max3_u32 v3, v3, v125, v126
v_max_u32 v3, v3, v127
v_cmp_eq_u32 vcc, -1, v3
s_cbranch_vccz VG_54
buffer_load_dwordx2 v[120:121], v2, s[4:7], s53 offen offset:0 sc1
buffer_load_dwordx2 v[122:123], v2, s[4:7], s53 offen offset:512 sc1
buffer_load_dwordx2 v[124:125], v2, s[4:7], s53 offen offset:1024 sc1
buffer_load_dwordx2 v[126:127], v2, s[4:7], s53 offen offset:1536 sc1
s_waitcnt vmcnt(0)
s_add_u32 s57, s57, 1
s_cmp_lt_u32 s57, 131072
s_cbranch_scc1 VL_53
v_mov_b32 v2, 27
v_mov_b32 v3, 200864
buffer_store_dword v2, v3, s[4:7], 0 offen sc1
s_waitcnt vmcnt(0)
s_endpgm
VG_54:
v_mfma_f32_16x16x16_bf16 v[160:163], v[120:121], v[232:233], v[160:163]
v_mfma_f32_16x16x16_bf16 v[164:167], v[120:121], v[236:237], v[164:167]
v_mfma_f32_16x16x16_bf16 v[168:171], v[122:123], v[232:233], v[168:171]
v_mfma_f32_16x16x16_bf16 v[172:175], v[122:123], v[236:237], v[172:175]
v_mfma_f32_16x16x16_bf16 v[176:179], v[124:125], v[232:233], v[176:179]
v_mfma_f32_16x16x16_bf16 v[180:183], v[124:125], v[236:237], v[180:183]
v_mfma_f32_16x16x16_bf16 v[184:187], v[126:127], v[232:233], v[184:187]
v_mfma_f32_16x16x16_bf16 v[188:191], v[126:127], v[236:237], v[188:191]
v_mfma_f32_16x16x16_bf16 v[192:195], v[120:121], v[234:235], v[192:195]
v_mfma_f32_16x16x16_bf16 v[196:199], v[120:121], v[238:239], v[196:199]
v_mfma_f32_16x16x16_bf16 v[200:203], v[122:123], v[234:235], v[200:203]
v_mfma_f32_16x16x16_bf16 v[204:207], v[122:123], v[238:239], v[204:207]
v_mfma_f32_16x16x16_bf16 v[208:211], v[124:125], v[234:235], v[208:211]
v_mfma_f32_16x16x16_bf16 v[212:215], v[124:125], v[238:239], v[212:215]
v_mfma_f32_16x16x16_bf16 v[216:219], v[126:127], v[234:235], v[216:219]
v_mfma_f32_16x16x16_bf16 v[220:223], v[126:127], v[238:239], v[220:223]
s_lshl_b32 s52, s50, 18
s_lshl_b32 s53, s51, 13
s_add_u32 s52, s52, s53
s_add_u32 s52, s52, 77594624
s_add_u32 s53, s52, 4096
v_mul_f32 v160, v160, v150
v_mul_f32 v164, v164, v151
v_mul_f32 v161, v161, v150
v_mul_f32 v165, v165, v151
v_mul_f32 v162, v162, v150
v_mul_f32 v166, v166, v151
v_mul_f32 v163, v163, v150
v_mul_f32 v167, v167, v151
v_cvt_pk_bf16_f32 v8, v160, v161
v_cvt_pk_bf16_f32 v9, v162, v163
v_cvt_pk_bf16_f32 v10, v164, v165
v_cvt_pk_bf16_f32 v11, v166, v167
s_nop 0
v_permlane16_swap_b32 v8, v10
v_permlane16_swap_b32 v9, v11
buffer_store_dwordx4 v[8:11], v1, s[4:7], s52 offen offset:0 sc1
v_mul_f32 v168, v168, v150
v_mul_f32 v172, v172, v151
v_mul_f32 v169, v169, v150
v_mul_f32 v173, v173, v151
v_mul_f32 v170, v170, v150
v_mul_f32 v174, v174, v151
v_mul_f32 v171, v171, v150
v_mul_f32 v175, v175, v151
v_cvt_pk_bf16_f32 v12, v168, v169
v_cvt_pk_bf16_f32 v13, v170, v171
v_cvt_pk_bf16_f32 v14, v172, v173
v_cvt_pk_bf16_f32 v15, v174, v175
s_nop 0
v_permlane16_swap_b32 v12, v14
v_permlane16_swap_b32 v13, v15
buffer_store_dwordx4 v[12:15], v1, s[4:7], s52 offen offset:1024 sc1
v_mul_f32 v176, v176, v150
v_mul_f32 v180, v180, v151
v_mul_f32 v177, v177, v150
v_mul_f32 v181, v181, v151
v_mul_f32 v178, v178, v150
v_mul_f32 v182, v182, v151
v_mul_f32 v179, v179, v150
v_mul_f32 v183, v183, v151
v_cvt_pk_bf16_f32 v16, v176, v177
v_cvt_pk_bf16_f32 v17, v178, v179
v_cvt_pk_bf16_f32 v18, v180, v181
v_cvt_pk_bf16_f32 v19, v182, v183
s_nop 0
v_permlane16_swap_b32 v16, v18
v_permlane16_swap_b32 v17, v19
buffer_store_dwordx4 v[16:19], v1, s[4:7], s52 offen offset:2048 sc1
v_mul_f32 v184, v184, v150
v_mul_f32 v188, v188, v151
v_mul_f32 v185, v185, v150
v_mul_f32 v189, v189, v151
v_mul_f32 v186, v186, v150
v_mul_f32 v190, v190, v151
v_mul_f32 v187, v187, v150
v_mul_f32 v191, v191, v151
v_cvt_pk_bf16_f32 v20, v184, v185
v_cvt_pk_bf16_f32 v21, v186, v187
v_cvt_pk_bf16_f32 v22, v188, v189
v_cvt_pk_bf16_f32 v23, v190, v191
s_nop 0
v_permlane16_swap_b32 v20, v22
v_permlane16_swap_b32 v21, v23
buffer_store_dwordx4 v[20:23], v1, s[4:7], s52 offen offset:3072 sc1
v_mul_f32 v192, v192, v150
v_mul_f32 v196, v196, v151
v_mul_f32 v193, v193, v150
v_mul_f32 v197, v197, v151
v_mul_f32 v194, v194, v150
v_mul_f32 v198, v198, v151
v_mul_f32 v195, v195, v150
v_mul_f32 v199, v199, v151
v_cvt_pk_bf16_f32 v24, v192, v193
v_cvt_pk_bf16_f32 v25, v194, v195
v_cvt_pk_bf16_f32 v26, v196, v197
v_cvt_pk_bf16_f32 v27, v198, v199
s_nop 0
v_permlane16_swap_b32 v24, v26
v_permlane16_swap_b32 v25, v27
buffer_store_dwordx4 v[24:27], v1, s[4:7], s53 offen offset:0 sc1
v_mul_f32 v200, v200, v150
v_mul_f32 v204, v204, v151
v_mul_f32 v201, v201, v150
v_mul_f32 v205, v205, v151
v_mul_f32 v202, v202, v150
v_mul_f32 v206, v206, v151
v_mul_f32 v203, v203, v150
v_mul_f32 v207, v207, v151
v_cvt_pk_bf16_f32 v28, v200, v201
v_cvt_pk_bf16_f32 v29, v202, v203
v_cvt_pk_bf16_f32 v30, v204, v205
v_cvt_pk_bf16_f32 v31, v206, v207
s_nop 0
v_permlane16_swap_b32 v28, v30
v_permlane16_swap_b32 v29, v31
buffer_store_dwordx4 v[28:31], v1, s[4:7], s53 offen offset:1024 sc1
v_mul_f32 v208, v208, v150
v_mul_f32 v212, v212, v151
v_mul_f32 v209, v209, v150
v_mul_f32 v213, v213, v151
v_mul_f32 v210, v210, v150
v_mul_f32 v214, v214, v151
v_mul_f32 v211, v211, v150
v_mul_f32 v215, v215, v151
v_cvt_pk_bf16_f32 v32, v208, v209
v_cvt_pk_bf16_f32 v33, v210, v211
v_cvt_pk_bf16_f32 v34, v212, v213
v_cvt_pk_bf16_f32 v35, v214, v215
s_nop 0
v_permlane16_swap_b32 v32, v34
v_permlane16_swap_b32 v33, v35
buffer_store_dwordx4 v[32:35], v1, s[4:7], s53 offen offset:2048 sc1
v_mul_f32 v216, v216, v150
v_mul_f32 v220, v220, v151
v_mul_f32 v217, v217, v150
v_mul_f32 v221, v221, v151
v_mul_f32 v218, v218, v150
v_mul_f32 v222, v222, v151
v_mul_f32 v219, v219, v150
v_mul_f32 v223, v223, v151
v_cvt_pk_bf16_f32 v36, v216, v217
v_cvt_pk_bf16_f32 v37, v218, v219
v_cvt_pk_bf16_f32 v38, v220, v221
v_cvt_pk_bf16_f32 v39, v222, v223
s_nop 0
v_permlane16_swap_b32 v36, v38
v_permlane16_swap_b32 v37, v39
buffer_store_dwordx4 v[36:39], v1, s[4:7], s53 offen offset:3072 sc1
s_lshl_b32 s52, s50, 7
s_add_u32 s52, s52, 11264
s_lshl_b32 s53, s51, 2
s_add_u32 s52, s52, s53
s_cmp_eq_u32 s50, 63
s_cbranch_scc1 AW_55
s_waitcnt vmcnt(0)
AW_55:
v_mov_b32 v2, 1
v_mov_b32 v3, 0
s_mov_b64 exec, 1
buffer_store_dword v2, v3, s[4:7], s52 offen sc1
s_mov_b64 exec, -1
s_add_u32 s50, s50, 8
s_cmp_lt_u32 s50, 64
s_cbranch_scc1 ATL
s_waitcnt vmcnt(0)
s_waitcnt vmcnt(0)
s_endpgm
WO:
s_sub_u32 s28, s25, 64
s_mul_i32 s50, s28, 3277
s_lshr_b32 s50, s50, 16
s_mul_i32 s29, s50, 20
s_sub_u32 s60, s28, s29
s_load_dwordx2 s[8:9], s[0:1], 40
s_waitcnt lgkmcnt(0)
s_mov_b32 s10, 5242880
s_mov_b32 s11, 0x20000
s_load_dwordx2 s[12:13], s[0:1], 0
s_waitcnt lgkmcnt(0)
s_mov_b32 s14, 2621440
s_mov_b32 s15, 0x20000
s_load_dwordx2 s[20:21], s[0:1], 88
s_waitcnt lgkmcnt(0)
s_mov_b32 s22, 2621440
s_mov_b32 s23, 0x20000
v_lshrrev_b32 v2, 2, v0
v_mul_u32_u24 v2, 1280, v2
v_and_b32 v3, 3, v0
v_lshl_add_u32 v2, v3, 4, v2
s_mul_i32 s52, s24, 1310720
s_lshl_b32 s53, s60, 6
s_add_u32 s52, s52, s53
s_lshl_b32 s53, s24, 15
v_lshrrev_b32 v4, 5, v0
v_lshlrev_b32 v4, 3, v4
v_bfe_u32 v5, v0, 2, 2
v_add_u32 v4, v4, v5
v_lshlrev_b32 v4, 6, v4
v_bfe_u32 v5, v0, 4, 1
v_lshl_add_u32 v4, v5, 5, v4
v_lshl_add_u32 v4, v3, 3, v4
v_add_u32 v4, s53, v4
s_mov_b32 m0, s53
s_nop 0
buffer_load_dwordx4 v2, s[8:11], s52 offen lds
s_add_u32 s52, s52, 20480
s_add_u32 m0, m0, 1024
s_nop 0
buffer_load_dwordx4 v2, s[8:11], s52 offen lds
s_add_u32 s52, s52, 20480
s_add_u32 m0, m0, 1024
s_nop 0
buffer_load_dwordx4 v2, s[8:11], s52 offen lds
s_add_u32 s52, s52, 20480
s_add_u32 m0, m0, 1024
s_nop 0
buffer_load_dwordx4 v2, s[8:11], s52 offen lds
s_add_u32 s52, s52, 20480
s_add_u32 m0, m0, 1024
s_nop 0
buffer_load_dwordx4 v2, s[8:11], s52 offen lds
s_add_u32 s52, s52, 20480
s_add_u32 m0, m0, 1024
s_nop 0
buffer_load_dwordx4 v2, s[8:11], s52 offen lds
s_add_u32 s52, s52, 20480
s_add_u32 m0, m0, 1024
s_nop 0
buffer_load_dwordx4 v2, s[8:11], s52 offen lds
s_add_u32 s52, s52, 20480
s_add_u32 m0, m0, 1024
s_nop 0
buffer_load_dwordx4 v2, s[8:11], s52 offen lds
s_add_u32 s52, s52, 20480
s_add_u32 m0, m0, 1024
s_nop 0
buffer_load_dwordx4 v2, s[8:11], s52 offen lds
s_add_u32 s52, s52, 20480
s_add_u32 m0, m0, 1024
s_nop 0
buffer_load_dwordx4 v2, s[8:11], s52 offen lds
s_add_u32 s52, s52, 20480
s_add_u32 m0, m0, 1024
s_nop 0
buffer_load_dwordx4 v2, s[8:11], s52 offen lds
s_add_u32 s52, s52, 20480
s_add_u32 m0, m0, 1024
s_nop 0
buffer_load_dwordx4 v2, s[8:11], s52 offen lds
s_add_u32 s52, s52, 20480
s_add_u32 m0, m0, 1024
s_nop 0
buffer_load_dwordx4 v2, s[8:11], s52 offen lds
s_add_u32 s52, s52, 20480
s_add_u32 m0, m0, 1024
s_nop 0
buffer_load_dwordx4 v2, s[8:11], s52 offen lds
s_add_u32 s52, s52, 20480
s_add_u32 m0, m0, 1024
s_nop 0
buffer_load_dwordx4 v2, s[8:11], s52 offen lds
s_add_u32 s52, s52, 20480
s_add_u32 m0, m0, 1024
s_nop 0
buffer_load_dwordx4 v2, s[8:11], s52 offen lds
s_add_u32 s52, s52, 20480
s_add_u32 m0, m0, 1024
s_nop 0
buffer_load_dwordx4 v2, s[8:11], s52 offen lds
s_add_u32 s52, s52, 20480
s_add_u32 m0, m0, 1024
s_nop 0
buffer_load_dwordx4 v2, s[8:11], s52 offen lds
s_add_u32 s52, s52, 20480
s_add_u32 m0, m0, 1024
s_nop 0
buffer_load_dwordx4 v2, s[8:11], s52 offen lds
s_add_u32 s52, s52, 20480
s_add_u32 m0, m0, 1024
s_nop 0
buffer_load_dwordx4 v2, s[8:11], s52 offen lds
s_add_u32 s52, s52, 20480
s_add_u32 m0, m0, 1024
s_nop 0
buffer_load_dwordx4 v2, s[8:11], s52 offen lds
s_add_u32 s52, s52, 20480
s_add_u32 m0, m0, 1024
s_nop 0
buffer_load_dwordx4 v2, s[8:11], s52 offen lds
s_add_u32 s52, s52, 20480
s_add_u32 m0, m0, 1024
s_nop 0
buffer_load_dwordx4 v2, s[8:11], s52 offen lds
s_add_u32 s52, s52, 20480
s_add_u32 m0, m0, 1024
s_nop 0
buffer_load_dwordx4 v2, s[8:11], s52 offen lds
s_add_u32 s52, s52, 20480
s_add_u32 m0, m0, 1024
s_nop 0
buffer_load_dwordx4 v2, s[8:11], s52 offen lds
s_add_u32 s52, s52, 20480
s_add_u32 m0, m0, 1024
s_nop 0
buffer_load_dwordx4 v2, s[8:11], s52 offen lds
s_add_u32 s52, s52, 20480
s_add_u32 m0, m0, 1024
s_nop 0
buffer_load_dwordx4 v2, s[8:11], s52 offen lds
s_add_u32 s52, s52, 20480
s_add_u32 m0, m0, 1024
s_nop 0
buffer_load_dwordx4 v2, s[8:11], s52 offen lds
s_add_u32 s52, s52, 20480
s_add_u32 m0, m0, 1024
s_nop 0
buffer_load_dwordx4 v2, s[8:11], s52 offen lds
s_add_u32 s52, s52, 20480
s_add_u32 m0, m0, 1024
s_nop 0
buffer_load_dwordx4 v2, s[8:11], s52 offen lds
s_add_u32 s52, s52, 20480
s_add_u32 m0, m0, 1024
s_nop 0
buffer_load_dwordx4 v2, s[8:11], s52 offen lds
s_add_u32 s52, s52, 20480
s_add_u32 m0, m0, 1024
s_nop 0
buffer_load_dwordx4 v2, s[8:11], s52 offen lds
s_add_u32 s52, s52, 20480
s_waitcnt vmcnt(0)
ds_read_b64_tr_b16 a[0:1], v4 offset:0
ds_read_b64_tr_b16 a[2:3], v4 offset:256
ds_read_b64_tr_b16 a[4:5], v4 offset:1024
ds_read_b64_tr_b16 a[6:7], v4 offset:1280
ds_read_b64_tr_b16 a[8:9], v4 offset:2048
ds_read_b64_tr_b16 a[10:11], v4 offset:2304
ds_read_b64_tr_b16 a[12:13], v4 offset:3072
ds_read_b64_tr_b16 a[14:15], v4 offset:3328
s_waitcnt lgkmcnt(4)
ds_read_b64_tr_b16 a[16:17], v4 offset:4096
ds_read_b64_tr_b16 a[18:19], v4 offset:4352
ds_read_b64_tr_b16 a[20:21], v4 offset:5120
ds_read_b64_tr_b16 a[22:23], v4 offset:5376
ds_read_b64_tr_b16 a[24:25], v4 offset:6144
ds_read_b64_tr_b16 a[26:27], v4 offset:6400
ds_read_b64_tr_b16 a[28:29], v4 offset:7168
ds_read_b64_tr_b16 a[30:31], v4 offset:7424
s_waitcnt lgkmcnt(4)
ds_read_b64_tr_b16 a[32:33], v4 offset:8192
ds_read_b64_tr_b16 a[34:35], v4 offset:8448
ds_read_b64_tr_b16 a[36:37], v4 offset:9216
ds_read_b64_tr_b16 a[38:39], v4 offset:9472
ds_read_b64_tr_b16 a[40:41], v4 offset:10240
ds_read_b64_tr_b16 a[42:43], v4 offset:10496
ds_read_b64_tr_b16 a[44:45], v4 offset:11264
ds_read_b64_tr_b16 a[46:47], v4 offset:11520
s_waitcnt lgkmcnt(4)
ds_read_b64_tr_b16 a[48:49], v4 offset:12288
ds_read_b64_tr_b16 a[50:51], v4 offset:12544
ds_read_b64_tr_b16 a[52:53], v4 offset:13312
ds_read_b64_tr_b16 a[54:55], v4 offset:13568
ds_read_b64_tr_b16 a[56:57], v4 offset:14336
ds_read_b64_tr_b16 a[58:59], v4 offset:14592
ds_read_b64_tr_b16 a[60:61], v4 offset:15360
ds_read_b64_tr_b16 a[62:63], v4 offset:15616
s_waitcnt lgkmcnt(4)
ds_read_b64_tr_b16 a[64:65], v4 offset:16384
ds_read_b64_tr_b16 a[66:67], v4 offset:16640
ds_read_b64_tr_b16 a[68:69], v4 offset:17408
ds_read_b64_tr_b16 a[70:71], v4 offset:17664
ds_read_b64_tr_b16 a[72:73], v4 offset:18432
ds_read_b64_tr_b16 a[74:75], v4 offset:18688
ds_read_b64_tr_b16 a[76:77], v4 offset:19456
ds_read_b64_tr_b16 a[78:79], v4 offset:19712
s_waitcnt lgkmcnt(4)
ds_read_b64_tr_b16 a[80:81], v4 offset:20480
ds_read_b64_tr_b16 a[82:83], v4 offset:20736
ds_read_b64_tr_b16 a[84:85], v4 offset:21504
ds_read_b64_tr_b16 a[86:87], v4 offset:21760
ds_read_b64_tr_b16 a[88:89], v4 offset:22528
ds_read_b64_tr_b16 a[90:91], v4 offset:22784
ds_read_b64_tr_b16 a[92:93], v4 offset:23552
ds_read_b64_tr_b16 a[94:95], v4 offset:23808
s_waitcnt lgkmcnt(4)
ds_read_b64_tr_b16 a[96:97], v4 offset:24576
ds_read_b64_tr_b16 a[98:99], v4 offset:24832
ds_read_b64_tr_b16 a[100:101], v4 offset:25600
ds_read_b64_tr_b16 a[102:103], v4 offset:25856
ds_read_b64_tr_b16 a[104:105], v4 offset:26624
ds_read_b64_tr_b16 a[106:107], v4 offset:26880
ds_read_b64_tr_b16 a[108:109], v4 offset:27648
ds_read_b64_tr_b16 a[110:111], v4 offset:27904
s_waitcnt lgkmcnt(4)
ds_read_b64_tr_b16 a[112:113], v4 offset:28672
ds_read_b64_tr_b16 a[114:115], v4 offset:28928
ds_read_b64_tr_b16 a[116:117], v4 offset:29696
ds_read_b64_tr_b16 a[118:119], v4 offset:29952
ds_read_b64_tr_b16 a[120:121], v4 offset:30720
ds_read_b64_tr_b16 a[122:123], v4 offset:30976
ds_read_b64_tr_b16 a[124:125], v4 offset:31744
ds_read_b64_tr_b16 a[126:127], v4 offset:32000
s_waitcnt lgkmcnt(4)
s_waitcnt lgkmcnt(0)
s_mov_b32 m0, s53
s_nop 0
buffer_load_dwordx4 v2, s[8:11], s52 offen lds
s_add_u32 s52, s52, 20480
s_add_u32 m0, m0, 1024
s_nop 0
buffer_load_dwordx4 v2, s[8:11], s52 offen lds
s_add_u32 s52, s52, 20480
s_add_u32 m0, m0, 1024
s_nop 0
buffer_load_dwordx4 v2, s[8:11], s52 offen lds
s_add_u32 s52, s52, 20480
s_add_u32 m0, m0, 1024
s_nop 0
buffer_load_dwordx4 v2, s[8:11], s52 offen lds
s_add_u32 s52, s52, 20480
s_add_u32 m0, m0, 1024
s_nop 0
buffer_load_dwordx4 v2, s[8:11], s52 offen lds
s_add_u32 s52, s52, 20480
s_add_u32 m0, m0, 1024
s_nop 0
buffer_load_dwordx4 v2, s[8:11], s52 offen lds
s_add_u32 s52, s52, 20480
s_add_u32 m0, m0, 1024
s_nop 0
buffer_load_dwordx4 v2, s[8:11], s52 offen lds
s_add_u32 s52, s52, 20480
s_add_u32 m0, m0, 1024
s_nop 0
buffer_load_dwordx4 v2, s[8:11], s52 offen lds
s_add_u32 s52, s52, 20480
s_add_u32 m0, m0, 1024
s_nop 0
buffer_load_dwordx4 v2, s[8:11], s52 offen lds
s_add_u32 s52, s52, 20480
s_add_u32 m0, m0, 1024
s_nop 0
buffer_load_dwordx4 v2, s[8:11], s52 offen lds
s_add_u32 s52, s52, 20480
s_add_u32 m0, m0, 1024
s_nop 0
buffer_load_dwordx4 v2, s[8:11], s52 offen lds
s_add_u32 s52, s52, 20480
s_add_u32 m0, m0, 1024
s_nop 0
buffer_load_dwordx4 v2, s[8:11], s52 offen lds
s_add_u32 s52, s52, 20480
s_add_u32 m0, m0, 1024
s_nop 0
buffer_load_dwordx4 v2, s[8:11], s52 offen lds
s_add_u32 s52, s52, 20480
s_add_u32 m0, m0, 1024
s_nop 0
buffer_load_dwordx4 v2, s[8:11], s52 offen lds
s_add_u32 s52, s52, 20480
s_add_u32 m0, m0, 1024
s_nop 0
buffer_load_dwordx4 v2, s[8:11], s52 offen lds
s_add_u32 s52, s52, 20480
s_add_u32 m0, m0, 1024
s_nop 0
buffer_load_dwordx4 v2, s[8:11], s52 offen lds
s_add_u32 s52, s52, 20480
s_add_u32 m0, m0, 1024
s_nop 0
buffer_load_dwordx4 v2, s[8:11], s52 offen lds
s_add_u32 s52, s52, 20480
s_add_u32 m0, m0, 1024
s_nop 0
buffer_load_dwordx4 v2, s[8:11], s52 offen lds
s_add_u32 s52, s52, 20480
s_add_u32 m0, m0, 1024
s_nop 0
buffer_load_dwordx4 v2, s[8:11], s52 offen lds
s_add_u32 s52, s52, 20480
s_add_u32 m0, m0, 1024
s_nop 0
buffer_load_dwordx4 v2, s[8:11], s52 offen lds
s_add_u32 s52, s52, 20480
s_add_u32 m0, m0, 1024
s_nop 0
buffer_load_dwordx4 v2, s[8:11], s52 offen lds
s_add_u32 s52, s52, 20480
s_add_u32 m0, m0, 1024
s_nop 0
buffer_load_dwordx4 v2, s[8:11], s52 offen lds
s_add_u32 s52, s52, 20480
s_add_u32 m0, m0, 1024
s_nop 0
buffer_load_dwordx4 v2, s[8:11], s52 offen lds
s_add_u32 s52, s52, 20480
s_add_u32 m0, m0, 1024
s_nop 0
buffer_load_dwordx4 v2, s[8:11], s52 offen lds
s_add_u32 s52, s52, 20480
s_add_u32 m0, m0, 1024
s_nop 0
buffer_load_dwordx4 v2, s[8:11], s52 offen lds
s_add_u32 s52, s52, 20480
s_add_u32 m0, m0, 1024
s_nop 0
buffer_load_dwordx4 v2, s[8:11], s52 offen lds
s_add_u32 s52, s52, 20480
s_add_u32 m0, m0, 1024
s_nop 0
buffer_load_dwordx4 v2, s[8:11], s52 offen lds
s_add_u32 s52, s52, 20480
s_add_u32 m0, m0, 1024
s_nop 0
buffer_load_dwordx4 v2, s[8:11], s52 offen lds
s_add_u32 s52, s52, 20480
s_add_u32 m0, m0, 1024
s_nop 0
buffer_load_dwordx4 v2, s[8:11], s52 offen lds
s_add_u32 s52, s52, 20480
s_add_u32 m0, m0, 1024
s_nop 0
buffer_load_dwordx4 v2, s[8:11], s52 offen lds
s_add_u32 s52, s52, 20480
s_add_u32 m0, m0, 1024
s_nop 0
buffer_load_dwordx4 v2, s[8:11], s52 offen lds
s_add_u32 s52, s52, 20480
s_add_u32 m0, m0, 1024
s_nop 0
buffer_load_dwordx4 v2, s[8:11], s52 offen lds
s_add_u32 s52, s52, 20480
s_waitcnt vmcnt(0)
ds_read_b64_tr_b16 a[128:129], v4 offset:0
ds_read_b64_tr_b16 a[130:131], v4 offset:256
ds_read_b64_tr_b16 a[132:133], v4 offset:1024
ds_read_b64_tr_b16 a[134:135], v4 offset:1280
ds_read_b64_tr_b16 a[136:137], v4 offset:2048
ds_read_b64_tr_b16 a[138:139], v4 offset:2304
ds_read_b64_tr_b16 a[140:141], v4 offset:3072
ds_read_b64_tr_b16 a[142:143], v4 offset:3328
s_waitcnt lgkmcnt(4)
ds_read_b64_tr_b16 a[144:145], v4 offset:4096
ds_read_b64_tr_b16 a[146:147], v4 offset:4352
ds_read_b64_tr_b16 a[148:149], v4 offset:5120
ds_read_b64_tr_b16 a[150:151], v4 offset:5376
ds_read_b64_tr_b16 a[152:153], v4 offset:6144
ds_read_b64_tr_b16 a[154:155], v4 offset:6400
ds_read_b64_tr_b16 a[156:157], v4 offset:7168
ds_read_b64_tr_b16 a[158:159], v4 offset:7424
s_waitcnt lgkmcnt(4)
ds_read_b64_tr_b16 a[160:161], v4 offset:8192
ds_read_b64_tr_b16 a[162:163], v4 offset:8448
ds_read_b64_tr_b16 a[164:165], v4 offset:9216
ds_read_b64_tr_b16 a[166:167], v4 offset:9472
ds_read_b64_tr_b16 a[168:169], v4 offset:10240
ds_read_b64_tr_b16 a[170:171], v4 offset:10496
ds_read_b64_tr_b16 a[172:173], v4 offset:11264
ds_read_b64_tr_b16 a[174:175], v4 offset:11520
s_waitcnt lgkmcnt(4)
ds_read_b64_tr_b16 a[176:177], v4 offset:12288
ds_read_b64_tr_b16 a[178:179], v4 offset:12544
ds_read_b64_tr_b16 a[180:181], v4 offset:13312
ds_read_b64_tr_b16 a[182:183], v4 offset:13568
ds_read_b64_tr_b16 a[184:185], v4 offset:14336
ds_read_b64_tr_b16 a[186:187], v4 offset:14592
ds_read_b64_tr_b16 a[188:189], v4 offset:15360
ds_read_b64_tr_b16 a[190:191], v4 offset:15616
s_waitcnt lgkmcnt(4)
ds_read_b64_tr_b16 a[192:193], v4 offset:16384
ds_read_b64_tr_b16 a[194:195], v4 offset:16640
ds_read_b64_tr_b16 a[196:197], v4 offset:17408
ds_read_b64_tr_b16 a[198:199], v4 offset:17664
ds_read_b64_tr_b16 a[200:201], v4 offset:18432
ds_read_b64_tr_b16 a[202:203], v4 offset:18688
ds_read_b64_tr_b16 a[204:205], v4 offset:19456
ds_read_b64_tr_b16 a[206:207], v4 offset:19712
s_waitcnt lgkmcnt(4)
ds_read_b64_tr_b16 a[208:209], v4 offset:20480
ds_read_b64_tr_b16 a[210:211], v4 offset:20736
ds_read_b64_tr_b16 a[212:213], v4 offset:21504
ds_read_b64_tr_b16 a[214:215], v4 offset:21760
ds_read_b64_tr_b16 a[216:217], v4 offset:22528
ds_read_b64_tr_b16 a[218:219], v4 offset:22784
ds_read_b64_tr_b16 a[220:221], v4 offset:23552
ds_read_b64_tr_b16 a[222:223], v4 offset:23808
s_waitcnt lgkmcnt(4)
ds_read_b64_tr_b16 a[224:225], v4 offset:24576
ds_read_b64_tr_b16 a[226:227], v4 offset:24832
ds_read_b64_tr_b16 a[228:229], v4 offset:25600
ds_read_b64_tr_b16 a[230:231], v4 offset:25856
ds_read_b64_tr_b16 a[232:233], v4 offset:26624
ds_read_b64_tr_b16 a[234:235], v4 offset:26880
ds_read_b64_tr_b16 a[236:237], v4 offset:27648
ds_read_b64_tr_b16 a[238:239], v4 offset:27904
s_waitcnt lgkmcnt(4)
ds_read_b64_tr_b16 a[240:241], v4 offset:28672
ds_read_b64_tr_b16 a[242:243], v4 offset:28928
ds_read_b64_tr_b16 a[244:245], v4 offset:29696
ds_read_b64_tr_b16 a[246:247], v4 offset:29952
ds_read_b64_tr_b16 a[248:249], v4 offset:30720
ds_read_b64_tr_b16 a[250:251], v4 offset:30976
ds_read_b64_tr_b16 a[252:253], v4 offset:31744
ds_read_b64_tr_b16 a[254:255], v4 offset:32000
s_waitcnt lgkmcnt(4)
s_waitcnt lgkmcnt(0)
s_barrier
v_lshlrev_b32 v1, 4, v0
v_and_b32 v2, 31, v0
v_mul_u32_u24 v2, 1280, v2
v_lshrrev_b32 v3, 5, v0
v_lshl_add_u32 v2, v3, 3, v2
s_lshl_b32 s52, s24, 4
s_lshl_b32 s53, s60, 6
s_add_u32 s52, s52, s53
v_add_u32 v8, s52, v2
s_mov_b32 s59, 0
s_mov_b64 s[62:63], -1
WOL:
s_lshr_b32 s52, s50, 2
s_lshl_b32 s52, s52, 7
s_add_u32 s52, s52, 9216
v_mbcnt_lo_u32_b32 v3, -1, 0
v_mbcnt_hi_u32_b32 v3, -1, v3
v_min_u32 v3, 4, v3
v_lshlrev_b32 v3, 2, v3
s_mov_b32 s28, 0
PL_56:
buffer_load_dword v2, v3, s[4:7], s52 offen sc1
s_waitcnt vmcnt(0)
v_cmp_eq_u32 vcc, 0, v2
s_cbranch_vccz PD_57
s_add_u32 s28, s28, 1
s_cmp_lt_u32 s28, 131072
s_cbranch_scc1 PL_56
v_mov_b32 v2, 23
v_mov_b32 v3, 200864
buffer_store_dword v2, v3, s[4:7], 0 offen sc1
s_waitcnt vmcnt(0)
s_endpgm
PD_57:
s_mul_i32 s55, s50, 40960
s_add_u32 s52, s55, 61865984
buffer_load_dwordx2 v[4:5], v8, s[12:15], s55 offen
buffer_load_dwordx2 v[6:7], v8, s[4:7], s52 offen sc1
s_lshl_b32 s52, s50, 7
s_add_u32 s52, s52, 11264
v_mbcnt_lo_u32_b32 v3, -1, 0
v_mbcnt_hi_u32_b32 v3, -1, v3
v_min_u32 v3, 31, v3
v_lshlrev_b32 v3, 2, v3
s_mov_b32 s28, 0
PL_58:
buffer_load_dword v2, v3, s[4:7], s52 offen sc1
s_waitcnt vmcnt(0)
v_cmp_eq_u32 vcc, 0, v2
s_cbranch_vccz PD_59
s_add_u32 s28, s28, 1
s_cmp_lt_u32 s28, 131072
s_cbranch_scc1 PL_58
v_mov_b32 v2, 24
v_mov_b32 v3, 200864
buffer_store_dword v2, v3, s[4:7], 0 offen sc1
s_waitcnt vmcnt(0)
s_endpgm
PD_59:
s_mov_b32 s57, 0
s_mov_b64 exec, s[62:63]
WR_60:
v_mov_b32 v10, 0
s_lshl_b32 s52, s50, 18
s_lshl_b32 s53, s24, 16
s_add_u32 s52, s52, s53
s_add_u32 s52, s52, 77594624
buffer_load_dwordx4 v[16:19], v1, s[4:7], s52 offen offset:0 sc1
buffer_load_dwordx4 v[20:23], v1, s[4:7], s52 offen offset:1024 sc1
buffer_load_dwordx4 v[24:27], v1, s[4:7], s52 offen offset:2048 sc1
buffer_load_dwordx4 v[28:31], v1, s[4:7], s52 offen offset:3072 sc1
s_add_u32 s52, s52, 4096
buffer_load_dwordx4 v[32:35], v1, s[4:7], s52 offen offset:0 sc1
buffer_load_dwordx4 v[36:39], v1, s[4:7], s52 offen offset:1024 sc1
buffer_load_dwordx4 v[40:43], v1, s[4:7], s52 offen offset:2048 sc1
buffer_load_dwordx4 v[44:47], v1, s[4:7], s52 offen offset:3072 sc1
s_add_u32 s52, s52, 4096
buffer_load_dwordx4 v[48:51], v1, s[4:7], s52 offen offset:0 sc1
buffer_load_dwordx4 v[52:55], v1, s[4:7], s52 offen offset:1024 sc1
buffer_load_dwordx4 v[56:59], v1, s[4:7], s52 offen offset:2048 sc1
buffer_load_dwordx4 v[60:63], v1, s[4:7], s52 offen offset:3072 sc1
s_add_u32 s52, s52, 4096
buffer_load_dwordx4 v[64:67], v1, s[4:7], s52 offen offset:0 sc1
buffer_load_dwordx4 v[68:71], v1, s[4:7], s52 offen offset:1024 sc1
buffer_load_dwordx4 v[72:75], v1, s[4:7], s52 offen offset:2048 sc1
buffer_load_dwordx4 v[76:79], v1, s[4:7], s52 offen offset:3072 sc1
s_add_u32 s52, s52, 4096
buffer_load_dwordx4 v[80:83], v1, s[4:7], s52 offen offset:0 sc1
buffer_load_dwordx4 v[84:87], v1, s[4:7], s52 offen offset:1024 sc1
buffer_load_dwordx4 v[88:91], v1, s[4:7], s52 offen offset:2048 sc1
buffer_load_dwordx4 v[92:95], v1, s[4:7], s52 offen offset:3072 sc1
s_add_u32 s52, s52, 4096
buffer_load_dwordx4 v[96:99], v1, s[4:7], s52 offen offset:0 sc1
buffer_load_dwordx4 v[100:103], v1, s[4:7], s52 offen offset:1024 sc1
buffer_load_dwordx4 v[104:107], v1, s[4:7], s52 offen offset:2048 sc1
buffer_load_dwordx4 v[108:111], v1, s[4:7], s52 offen offset:3072 sc1
s_add_u32 s52, s52, 4096
buffer_load_dwordx4 v[112:115], v1, s[4:7], s52 offen offset:0 sc1
buffer_load_dwordx4 v[116:119], v1, s[4:7], s52 offen offset:1024 sc1
buffer_load_dwordx4 v[120:123], v1, s[4:7], s52 offen offset:2048 sc1
buffer_load_dwordx4 v[124:127], v1, s[4:7], s52 offen offset:3072 sc1
s_add_u32 s52, s52, 4096
buffer_load_dwordx4 v[128:131], v1, s[4:7], s52 offen offset:0 sc1
buffer_load_dwordx4 v[132:135], v1, s[4:7], s52 offen offset:1024 sc1
buffer_load_dwordx4 v[136:139], v1, s[4:7], s52 offen offset:2048 sc1
buffer_load_dwordx4 v[140:143], v1, s[4:7], s52 offen offset:3072 sc1
s_add_u32 s52, s52, 4096
buffer_load_dwordx4 v[144:147], v1, s[4:7], s52 offen offset:0 sc1
buffer_load_dwordx4 v[148:151], v1, s[4:7], s52 offen offset:1024 sc1
buffer_load_dwordx4 v[152:155], v1, s[4:7], s52 offen offset:2048 sc1
buffer_load_dwordx4 v[156:159], v1, s[4:7], s52 offen offset:3072 sc1
s_add_u32 s52, s52, 4096
buffer_load_dwordx4 v[160:163], v1, s[4:7], s52 offen offset:0 sc1
buffer_load_dwordx4 v[164:167], v1, s[4:7], s52 offen offset:1024 sc1
buffer_load_dwordx4 v[168:171], v1, s[4:7], s52 offen offset:2048 sc1
buffer_load_dwordx4 v[172:175], v1, s[4:7], s52 offen offset:3072 sc1
s_add_u32 s52, s52, 4096
buffer_load_dwordx4 v[176:179], v1, s[4:7], s52 offen offset:0 sc1
buffer_load_dwordx4 v[180:183], v1, s[4:7], s52 offen offset:1024 sc1
buffer_load_dwordx4 v[184:187], v1, s[4:7], s52 offen offset:2048 sc1
buffer_load_dwordx4 v[188:191], v1, s[4:7], s52 offen offset:3072 sc1
s_add_u32 s52, s52, 4096
buffer_load_dwordx4 v[192:195], v1, s[4:7], s52 offen offset:0 sc1
buffer_load_dwordx4 v[196:199], v1, s[4:7], s52 offen offset:1024 sc1
buffer_load_dwordx4 v[200:203], v1, s[4:7], s52 offen offset:2048 sc1
buffer_load_dwordx4 v[204:207], v1, s[4:7], s52 offen offset:3072 sc1
s_add_u32 s52, s52, 4096
buffer_load_dwordx4 v[208:211], v1, s[4:7], s52 offen offset:0 sc1
buffer_load_dwordx4 v[212:215], v1, s[4:7], s52 offen offset:1024 sc1
buffer_load_dwordx4 v[216:219], v1, s[4:7], s52 offen offset:2048 sc1
buffer_load_dwordx4 v[220:223], v1, s[4:7], s52 offen offset:3072 sc1
s_add_u32 s52, s52, 4096
buffer_load_dwordx4 v[224:227], v1, s[4:7], s52 offen offset:0 sc1
buffer_load_dwordx4 v[228:231], v1, s[4:7], s52 offen offset:1024 sc1
buffer_load_dwordx4 v[232:235], v1, s[4:7], s52 offen offset:2048 sc1
buffer_load_dwordx4 v[236:239], v1, s[4:7], s52 offen offset:3072 sc1
s_add_u32 s52, s52, 4096
s_waitcnt vmcnt(55)
v_mfma_f32_32x32x16_bf16 v[240:255], a[0:3], v[16:19], 0
v_max3_u32 v10, v10, v16, v17
v_max3_u32 v10, v10, v18, v19
buffer_load_dwordx4 v[16:19], v1, s[4:7], s52 offen offset:0 sc1
s_waitcnt vmcnt(55)
v_mfma_f32_32x32x16_bf16 v[240:255], a[4:7], v[20:23], v[240:255]
v_max3_u32 v10, v10, v20, v21
v_max3_u32 v10, v10, v22, v23
buffer_load_dwordx4 v[20:23], v1, s[4:7], s52 offen offset:1024 sc1
s_waitcnt vmcnt(55)
v_mfma_f32_32x32x16_bf16 v[240:255], a[8:11], v[24:27], v[240:255]
v_max3_u32 v10, v10, v24, v25
v_max3_u32 v10, v10, v26, v27
buffer_load_dwordx4 v[24:27], v1, s[4:7], s52 offen offset:2048 sc1
s_waitcnt vmcnt(55)
v_mfma_f32_32x32x16_bf16 v[240:255], a[12:15], v[28:31], v[240:255]
v_max3_u32 v10, v10, v28, v29
v_max3_u32 v10, v10, v30, v31
buffer_load_dwordx4 v[28:31], v1, s[4:7], s52 offen offset:3072 sc1
s_add_u32 s52, s52, 4096
s_waitcnt vmcnt(55)
v_mfma_f32_32x32x16_bf16 v[240:255], a[16:19], v[32:35], v[240:255]
v_max3_u32 v10, v10, v32, v33
v_max3_u32 v10, v10, v34, v35
buffer_load_dwordx4 v[32:35], v1, s[4:7], s52 offen offset:0 sc1
s_waitcnt vmcnt(55)
v_mfma_f32_32x32x16_bf16 v[240:255], a[20:23], v[36:39], v[240:255]
v_max3_u32 v10, v10, v36, v37
v_max3_u32 v10, v10, v38, v39
buffer_load_dwordx4 v[36:39], v1, s[4:7], s52 offen offset:1024 sc1
s_waitcnt vmcnt(55)
v_mfma_f32_32x32x16_bf16 v[240:255], a[24:27], v[40:43], v[240:255]
v_max3_u32 v10, v10, v40, v41
v_max3_u32 v10, v10, v42, v43
buffer_load_dwordx4 v[40:43], v1, s[4:7], s52 offen offset:2048 sc1
s_waitcnt vmcnt(55)
v_mfma_f32_32x32x16_bf16 v[240:255], a[28:31], v[44:47], v[240:255]
v_max3_u32 v10, v10, v44, v45
v_max3_u32 v10, v10, v46, v47
buffer_load_dwordx4 v[44:47], v1, s[4:7], s52 offen offset:3072 sc1
s_add_u32 s52, s52, 4096
s_waitcnt vmcnt(55)
v_mfma_f32_32x32x16_bf16 v[240:255], a[32:35], v[48:51], v[240:255]
v_max3_u32 v10, v10, v48, v49
v_max3_u32 v10, v10, v50, v51
s_waitcnt vmcnt(54)
v_mfma_f32_32x32x16_bf16 v[240:255], a[36:39], v[52:55], v[240:255]
v_max3_u32 v10, v10, v52, v53
v_max3_u32 v10, v10, v54, v55
s_waitcnt vmcnt(53)
v_mfma_f32_32x32x16_bf16 v[240:255], a[40:43], v[56:59], v[240:255]
v_max3_u32 v10, v10, v56, v57
v_max3_u32 v10, v10, v58, v59
s_waitcnt vmcnt(52)
v_mfma_f32_32x32x16_bf16 v[240:255], a[44:47], v[60:63], v[240:255]
v_max3_u32 v10, v10, v60, v61
v_max3_u32 v10, v10, v62, v63
s_waitcnt vmcnt(51)
v_mfma_f32_32x32x16_bf16 v[240:255], a[48:51], v[64:67], v[240:255]
v_max3_u32 v10, v10, v64, v65
v_max3_u32 v10, v10, v66, v67
s_waitcnt vmcnt(50)
v_mfma_f32_32x32x16_bf16 v[240:255], a[52:55], v[68:71], v[240:255]
v_max3_u32 v10, v10, v68, v69
v_max3_u32 v10, v10, v70, v71
s_waitcnt vmcnt(49)
v_mfma_f32_32x32x16_bf16 v[240:255], a[56:59], v[72:75], v[240:255]
v_max3_u32 v10, v10, v72, v73
v_max3_u32 v10, v10, v74, v75
s_waitcnt vmcnt(48)
v_mfma_f32_32x32x16_bf16 v[240:255], a[60:63], v[76:79], v[240:255]
v_max3_u32 v10, v10, v76, v77
v_max3_u32 v10, v10, v78, v79
s_waitcnt vmcnt(47)
v_mfma_f32_32x32x16_bf16 v[240:255], a[64:67], v[80:83], v[240:255]
v_max3_u32 v10, v10, v80, v81
v_max3_u32 v10, v10, v82, v83
s_waitcnt vmcnt(46)
v_mfma_f32_32x32x16_bf16 v[240:255], a[68:71], v[84:87], v[240:255]
v_max3_u32 v10, v10, v84, v85
v_max3_u32 v10, v10, v86, v87
s_waitcnt vmcnt(45)
v_mfma_f32_32x32x16_bf16 v[240:255], a[72:75], v[88:91], v[240:255]
v_max3_u32 v10, v10, v88, v89
v_max3_u32 v10, v10, v90, v91
s_waitcnt vmcnt(44)
v_mfma_f32_32x32x16_bf16 v[240:255], a[76:79], v[92:95], v[240:255]
v_max3_u32 v10, v10, v92, v93
v_max3_u32 v10, v10, v94, v95
s_waitcnt vmcnt(43)
v_mfma_f32_32x32x16_bf16 v[240:255], a[80:83], v[96:99], v[240:255]
v_max3_u32 v10, v10, v96, v97
v_max3_u32 v10, v10, v98, v99
s_waitcnt vmcnt(42)
v_mfma_f32_32x32x16_bf16 v[240:255], a[84:87], v[100:103], v[240:255]
v_max3_u32 v10, v10, v100, v101
v_max3_u32 v10, v10, v102, v103
s_waitcnt vmcnt(41)
v_mfma_f32_32x32x16_bf16 v[240:255], a[88:91], v[104:107], v[240:255]
v_max3_u32 v10, v10, v104, v105
v_max3_u32 v10, v10, v106, v107
s_waitcnt vmcnt(40)
v_mfma_f32_32x32x16_bf16 v[240:255], a[92:95], v[108:111], v[240:255]
v_max3_u32 v10, v10, v108, v109
v_max3_u32 v10, v10, v110, v111
s_waitcnt vmcnt(39)
v_mfma_f32_32x32x16_bf16 v[240:255], a[96:99], v[112:115], v[240:255]
v_max3_u32 v10, v10, v112, v113
v_max3_u32 v10, v10, v114, v115
s_waitcnt vmcnt(38)
v_mfma_f32_32x32x16_bf16 v[240:255], a[100:103], v[116:119], v[240:255]
v_max3_u32 v10, v10, v116, v117
v_max3_u32 v10, v10, v118, v119
s_waitcnt vmcnt(37)
v_mfma_f32_32x32x16_bf16 v[240:255], a[104:107], v[120:123], v[240:255]
v_max3_u32 v10, v10, v120, v121
v_max3_u32 v10, v10, v122, v123
s_waitcnt vmcnt(36)
v_mfma_f32_32x32x16_bf16 v[240:255], a[108:111], v[124:127], v[240:255]
v_max3_u32 v10, v10, v124, v125
v_max3_u32 v10, v10, v126, v127
s_waitcnt vmcnt(35)
v_mfma_f32_32x32x16_bf16 v[240:255], a[112:115], v[128:131], v[240:255]
v_max3_u32 v10, v10, v128, v129
v_max3_u32 v10, v10, v130, v131
s_waitcnt vmcnt(34)
v_mfma_f32_32x32x16_bf16 v[240:255], a[116:119], v[132:135], v[240:255]
v_max3_u32 v10, v10, v132, v133
v_max3_u32 v10, v10, v134, v135
s_waitcnt vmcnt(33)
v_mfma_f32_32x32x16_bf16 v[240:255], a[120:123], v[136:139], v[240:255]
v_max3_u32 v10, v10, v136, v137
v_max3_u32 v10, v10, v138, v139
s_waitcnt vmcnt(32)
v_mfma_f32_32x32x16_bf16 v[240:255], a[124:127], v[140:143], v[240:255]
v_max3_u32 v10, v10, v140, v141
v_max3_u32 v10, v10, v142, v143
s_waitcnt vmcnt(31)
v_mfma_f32_32x32x16_bf16 v[240:255], a[128:131], v[144:147], v[240:255]
v_max3_u32 v10, v10, v144, v145
v_max3_u32 v10, v10, v146, v147
s_waitcnt vmcnt(30)
v_mfma_f32_32x32x16_bf16 v[240:255], a[132:135], v[148:151], v[240:255]
v_max3_u32 v10, v10, v148, v149
v_max3_u32 v10, v10, v150, v151
s_waitcnt vmcnt(29)
v_mfma_f32_32x32x16_bf16 v[240:255], a[136:139], v[152:155], v[240:255]
v_max3_u32 v10, v10, v152, v153
v_max3_u32 v10, v10, v154, v155
s_waitcnt vmcnt(28)
v_mfma_f32_32x32x16_bf16 v[240:255], a[140:143], v[156:159], v[240:255]
v_max3_u32 v10, v10, v156, v157
v_max3_u32 v10, v10, v158, v159
s_waitcnt vmcnt(27)
v_mfma_f32_32x32x16_bf16 v[240:255], a[144:147], v[160:163], v[240:255]
v_max3_u32 v10, v10, v160, v161
v_max3_u32 v10, v10, v162, v163
s_waitcnt vmcnt(26)
v_mfma_f32_32x32x16_bf16 v[240:255], a[148:151], v[164:167], v[240:255]
v_max3_u32 v10, v10, v164, v165
v_max3_u32 v10, v10, v166, v167
s_waitcnt vmcnt(25)
v_mfma_f32_32x32x16_bf16 v[240:255], a[152:155], v[168:171], v[240:255]
v_max3_u32 v10, v10, v168, v169
v_max3_u32 v10, v10, v170, v171
s_waitcnt vmcnt(24)
v_mfma_f32_32x32x16_bf16 v[240:255], a[156:159], v[172:175], v[240:255]
v_max3_u32 v10, v10, v172, v173
v_max3_u32 v10, v10, v174, v175
s_waitcnt vmcnt(23)
v_mfma_f32_32x32x16_bf16 v[240:255], a[160:163], v[176:179], v[240:255]
v_max3_u32 v10, v10, v176, v177
v_max3_u32 v10, v10, v178, v179
s_waitcnt vmcnt(22)
v_mfma_f32_32x32x16_bf16 v[240:255], a[164:167], v[180:183], v[240:255]
v_max3_u32 v10, v10, v180, v181
v_max3_u32 v10, v10, v182, v183
s_waitcnt vmcnt(21)
v_mfma_f32_32x32x16_bf16 v[240:255], a[168:171], v[184:187], v[240:255]
v_max3_u32 v10, v10, v184, v185
v_max3_u32 v10, v10, v186, v187
s_waitcnt vmcnt(20)
v_mfma_f32_32x32x16_bf16 v[240:255], a[172:175], v[188:191], v[240:255]
v_max3_u32 v10, v10, v188, v189
v_max3_u32 v10, v10, v190, v191
s_waitcnt vmcnt(19)
v_mfma_f32_32x32x16_bf16 v[240:255], a[176:179], v[192:195], v[240:255]
v_max3_u32 v10, v10, v192, v193
v_max3_u32 v10, v10, v194, v195
s_waitcnt vmcnt(18)
v_mfma_f32_32x32x16_bf16 v[240:255], a[180:183], v[196:199], v[240:255]
v_max3_u32 v10, v10, v196, v197
v_max3_u32 v10, v10, v198, v199
s_waitcnt vmcnt(17)
v_mfma_f32_32x32x16_bf16 v[240:255], a[184:187], v[200:203], v[240:255]
v_max3_u32 v10, v10, v200, v201
v_max3_u32 v10, v10, v202, v203
s_waitcnt vmcnt(16)
v_mfma_f32_32x32x16_bf16 v[240:255], a[188:191], v[204:207], v[240:255]
v_max3_u32 v10, v10, v204, v205
v_max3_u32 v10, v10, v206, v207
s_waitcnt vmcnt(15)
v_mfma_f32_32x32x16_bf16 v[240:255], a[192:195], v[208:211], v[240:255]
v_max3_u32 v10, v10, v208, v209
v_max3_u32 v10, v10, v210, v211
s_waitcnt vmcnt(14)
v_mfma_f32_32x32x16_bf16 v[240:255], a[196:199], v[212:215], v[240:255]
v_max3_u32 v10, v10, v212, v213
v_max3_u32 v10, v10, v214, v215
s_waitcnt vmcnt(13)
v_mfma_f32_32x32x16_bf16 v[240:255], a[200:203], v[216:219], v[240:255]
v_max3_u32 v10, v10, v216, v217
v_max3_u32 v10, v10, v218, v219
s_waitcnt vmcnt(12)
v_mfma_f32_32x32x16_bf16 v[240:255], a[204:207], v[220:223], v[240:255]
v_max3_u32 v10, v10, v220, v221
v_max3_u32 v10, v10, v222, v223
s_waitcnt vmcnt(11)
v_mfma_f32_32x32x16_bf16 v[240:255], a[208:211], v[224:227], v[240:255]
v_max3_u32 v10, v10, v224, v225
v_max3_u32 v10, v10, v226, v227
s_waitcnt vmcnt(10)
v_mfma_f32_32x32x16_bf16 v[240:255], a[212:215], v[228:231], v[240:255]
v_max3_u32 v10, v10, v228, v229
v_max3_u32 v10, v10, v230, v231
s_waitcnt vmcnt(9)
v_mfma_f32_32x32x16_bf16 v[240:255], a[216:219], v[232:235], v[240:255]
v_max3_u32 v10, v10, v232, v233
v_max3_u32 v10, v10, v234, v235
s_waitcnt vmcnt(8)
v_mfma_f32_32x32x16_bf16 v[240:255], a[220:223], v[236:239], v[240:255]
v_max3_u32 v10, v10, v236, v237
v_max3_u32 v10, v10, v238, v239
s_waitcnt vmcnt(7)
v_mfma_f32_32x32x16_bf16 v[240:255], a[224:227], v[16:19], v[240:255]
v_max3_u32 v10, v10, v16, v17
v_max3_u32 v10, v10, v18, v19
s_waitcnt vmcnt(6)
v_mfma_f32_32x32x16_bf16 v[240:255], a[228:231], v[20:23], v[240:255]
v_max3_u32 v10, v10, v20, v21
v_max3_u32 v10, v10, v22, v23
s_waitcnt vmcnt(5)
v_mfma_f32_32x32x16_bf16 v[240:255], a[232:235], v[24:27], v[240:255]
v_max3_u32 v10, v10, v24, v25
v_max3_u32 v10, v10, v26, v27
s_waitcnt vmcnt(4)
v_mfma_f32_32x32x16_bf16 v[240:255], a[236:239], v[28:31], v[240:255]
v_max3_u32 v10, v10, v28, v29
v_max3_u32 v10, v10, v30, v31
s_waitcnt vmcnt(3)
v_mfma_f32_32x32x16_bf16 v[240:255], a[240:243], v[32:35], v[240:255]
v_max3_u32 v10, v10, v32, v33
v_max3_u32 v10, v10, v34, v35
s_waitcnt vmcnt(2)
v_mfma_f32_32x32x16_bf16 v[240:255], a[244:247], v[36:39], v[240:255]
v_max3_u32 v10, v10, v36, v37
v_max3_u32 v10, v10, v38, v39
s_waitcnt vmcnt(1)
v_mfma_f32_32x32x16_bf16 v[240:255], a[248:251], v[40:43], v[240:255]
v_max3_u32 v10, v10, v40, v41
v_max3_u32 v10, v10, v42, v43
s_waitcnt vmcnt(0)
v_mfma_f32_32x32x16_bf16 v[240:255], a[252:255], v[44:47], v[240:255]
v_max3_u32 v10, v10, v44, v45
v_max3_u32 v10, v10, v46, v47
s_cmp_lg_u32 s50, 63
s_cbranch_scc1 WG_61
v_cmp_eq_u32 vcc, -1, v10
s_cbranch_vccz WG_61
s_add_u32 s57, s57, 1
s_cmp_lt_u32 s57, 131072
s_cbranch_scc1 WR_60
v_mov_b32 v2, 26
v_mov_b32 v3, 200864
buffer_store_dword v2, v3, s[4:7], 0 offen sc1
s_waitcnt vmcnt(0)
s_endpgm
WG_61:
s_mov_b64 exec, -1
s_lshl_b32 s52, s24, 12
s_add_u32 s52, s52, s59
v_add_u32 v9, s52, v1
s_nop 3
ds_write_b128 v9, v[240:243] offset:0
ds_write_b128 v9, v[244:247] offset:1024
ds_write_b128 v9, v[248:251] offset:2048
ds_write_b128 v9, v[252:255] offset:3072
s_lshl_b32 s52, s24, 10
s_add_u32 s52, s52, s59
v_add_u32 v9, s52, v1
s_waitcnt lgkmcnt(0)
s_barrier
ds_read_b128 v[16:19], v9 offset:0
ds_read_b128 v[20:23], v9 offset:4096
ds_read_b128 v[24:27], v9 offset:8192
ds_read_b128 v[28:31], v9 offset:12288
v_lshlrev_b32 v32, 16, v4
v_and_b32 v33, 0xffff0000, v4
v_lshlrev_b32 v34, 16, v5
v_and_b32 v35, 0xffff0000, v5
v_lshlrev_b32 v36, 16, v6
v_and_b32 v37, 0xffff0000, v6
v_lshlrev_b32 v38, 16, v7
v_and_b32 v39, 0xffff0000, v7
s_waitcnt lgkmcnt(0)
v_add_f32 v16, v16, v20
v_add_f32 v24, v24, v28
v_add_f32 v17, v17, v21
v_add_f32 v25, v25, v29
v_add_f32 v18, v18, v22
v_add_f32 v26, v26, v30
v_add_f32 v19, v19, v23
v_add_f32 v27, v27, v31
v_add_f32 v16, v16, v24
v_add_f32 v17, v17, v25
v_add_f32 v18, v18, v26
v_add_f32 v19, v19, v27
v_cvt_pk_bf16_f32 v20, v16, v17
v_cvt_pk_bf16_f32 v21, v18, v19
v_lshlrev_b32 v16, 16, v20
v_and_b32 v17, 0xffff0000, v20
v_lshlrev_b32 v18, 16, v21
v_and_b32 v19, 0xffff0000, v21
v_mul_f32 v16, v16, v36
v_mul_f32 v17, v17, v37
v_mul_f32 v18, v18, v38
v_mul_f32 v19, v19, v39
v_cvt_pk_bf16_f32 v20, v16, v17
v_cvt_pk_bf16_f32 v21, v18, v19
v_lshlrev_b32 v16, 16, v20
v_and_b32 v17, 0xffff0000, v20
v_lshlrev_b32 v18, 16, v21
v_and_b32 v19, 0xffff0000, v21
v_add_f32 v16, v16, v32
v_add_f32 v17, v17, v33
v_add_f32 v18, v18, v34
v_add_f32 v19, v19, v35
v_cvt_pk_bf16_f32 v20, v16, v17
v_cvt_pk_bf16_f32 v21, v18, v19
s_mov_b64 exec, s[62:63]
buffer_store_dwordx2 v[20:21], v8, s[20:23], s55 offen
s_mov_b64 exec, -1
s_xor_b32 s59, s59, 16384
s_cmp_eq_u32 s50, 63
s_cbranch_scc1 WOE
s_add_u32 s50, s50, 6
s_cmp_lt_u32 s50, 63
s_cbranch_scc1 WOL
s_cmp_gt_u32 s50, 66
s_cbranch_scc1 WOE
s_sub_u32 s28, s50, 63
s_lshl_b32 s28, s28, 3
s_lshl_b32 s62, 0xff, s28
s_mov_b32 s63, s62
s_mov_b32 s50, 63
s_branch WOL
WOE:
s_waitcnt vmcnt(0)
s_waitcnt vmcnt(0)
s_endpgm
s_endpgm
REC:
v_and_b32 v0, 63, v0
s_load_dwordx2 s[8:9], s[0:1], 16
s_load_dwordx2 s[12:13], s[0:1], 24
s_load_dwordx2 s[16:17], s[0:1], 32
s_load_dwordx2 s[20:21], s[0:1], 40
s_mov_b32 s10, 5242880
s_mov_b32 s11, 0x20000
s_mov_b32 s14, 5242880
s_mov_b32 s15, 0x20000
s_mov_b32 s18, 5242880
s_mov_b32 s19, 0x20000
s_mov_b32 s22, 5242880
s_mov_b32 s23, 0x20000
s_waitcnt lgkmcnt(0)
v_lshrrev_b32 v2, 3, v0
s_lshl_b32 s28, s24, 4
v_add_u32 v2, s28, v2
v_bfe_u32 v3, v0, 1, 2
v_lshrrev_b32 v4, 5, v0
v_and_b32 v5, 1, v0
v_add_u32 v6, 0, v4
v_and_b32 v6, 3, v6
v_xor_b32 v6, v6, v3
v_lshl_or_b32 v6, v6, 1, v5
v_lshlrev_b32 v6, 4, v6
v_add_u32 v7, 0, v2
v_lshl_add_u32 v58, v7, 13, v6
v_mul_u32_u24 v7, 1280, v7
v_add_u32 v60, v7, v6
v_subrev_u32 v58, 0, v58
v_subrev_u32 v60, 0, v60
v_add_u32 v6, 2, v4
v_and_b32 v6, 3, v6
v_xor_b32 v6, v6, v3
v_lshl_or_b32 v6, v6, 1, v5
v_lshlrev_b32 v6, 4, v6
v_add_u32 v7, 8, v2
v_lshl_add_u32 v59, v7, 13, v6
v_mul_u32_u24 v7, 1280, v7
v_add_u32 v61, v7, v6
v_subrev_u32 v59, 1024, v59
v_subrev_u32 v61, 1024, v61
v_lshrrev_b32 v2, 5, v0
v_lshlrev_b32 v2, 4, v2
v_bfe_u32 v3, v0, 4, 1
v_lshl_add_u32 v2, v3, 2, v2
v_bfe_u32 v4, v0, 2, 1
v_add_u32 v2, v2, v4
v_bfe_u32 v4, v0, 3, 1
v_lshl_add_u32 v2, v4, 3, v2
v_lshlrev_b32 v2, 7, v2
v_lshl_add_u32 v3, v4, 1, v3
v_xor_b32 v3, s24, v3
v_lshl_add_u32 v2, v3, 5, v2
v_and_b32 v3, 3, v0
v_lshl_add_u32 v62, v3, 3, v2
v_add_u32 v63, 0x10000, v62
s_lshl_b32 s28, s24, 11
v_lshl_add_u32 v64, v0, 4, s28
v_add_u32 v65, 0x10000, v64
s_lshl_b32 s40, s25, 8
s_mul_i32 s41, s26, 2621440
s_sub_u32 s42, 2621440, s41
s_add_u32 s41, s41, s40
s_add_u32 s42, s42, s40
s_mul_i32 s43, s25, 163840
s_mul_i32 s44, s26, 640
s_add_u32 s43, s43, s44
s_lshl_b32 s45, s24, 11
s_add_u32 s28, s41, 0
s_add_u32 m0, s45, 0
s_nop 0
buffer_load_dwordx4 v58, s[8:11], s28 offen offset:0 lds
buffer_load_dwordx4 v59, s[8:11], s28 offen offset:1024 lds
s_add_u32 s28, s41, 128
s_add_u32 m0, s45, 8192
s_nop 0
buffer_load_dwordx4 v58, s[8:11], s28 offen offset:0 lds
buffer_load_dwordx4 v59, s[8:11], s28 offen offset:1024 lds
s_add_u32 s28, s41, 0
s_add_u32 m0, s45, 16384
s_nop 0
buffer_load_dwordx4 v58, s[12:15], s28 offen offset:0 lds
buffer_load_dwordx4 v59, s[12:15], s28 offen offset:1024 lds
s_add_u32 s28, s41, 128
s_add_u32 m0, s45, 24576
s_nop 0
buffer_load_dwordx4 v58, s[12:15], s28 offen offset:0 lds
buffer_load_dwordx4 v59, s[12:15], s28 offen offset:1024 lds
s_add_u32 s28, s41, 0
s_add_u32 m0, s45, 32768
s_nop 0
buffer_load_dwordx4 v58, s[16:19], s28 offen offset:0 lds
buffer_load_dwordx4 v59, s[16:19], s28 offen offset:1024 lds
s_add_u32 s28, s41, 524288
s_add_u32 m0, s45, 40960
s_nop 0
buffer_load_dwordx4 v58, s[8:11], s28 offen offset:0 lds
buffer_load_dwordx4 v59, s[8:11], s28 offen offset:1024 lds
s_add_u32 s28, s41, 524416
s_add_u32 m0, s45, 49152
s_nop 0
buffer_load_dwordx4 v58, s[8:11], s28 offen offset:0 lds
buffer_load_dwordx4 v59, s[8:11], s28 offen offset:1024 lds
s_add_u32 s28, s41, 524288
s_add_u32 m0, s45, 57344
s_nop 0
buffer_load_dwordx4 v58, s[12:15], s28 offen offset:0 lds
buffer_load_dwordx4 v59, s[12:15], s28 offen offset:1024 lds
s_add_u32 s28, s41, 524416
s_add_u32 m0, s45, 65536
s_nop 0
buffer_load_dwordx4 v58, s[12:15], s28 offen offset:0 lds
buffer_load_dwordx4 v59, s[12:15], s28 offen offset:1024 lds
s_add_u32 s28, s41, 524288
s_add_u32 m0, s45, 73728
s_nop 0
buffer_load_dwordx4 v58, s[16:19], s28 offen offset:0 lds
buffer_load_dwordx4 v59, s[16:19], s28 offen offset:1024 lds
s_add_u32 s28, s41, 1048576
s_add_u32 m0, s45, 81920
s_nop 0
buffer_load_dwordx4 v58, s[8:11], s28 offen offset:0 lds
buffer_load_dwordx4 v59, s[8:11], s28 offen offset:1024 lds
s_add_u32 s28, s41, 1048704
s_add_u32 m0, s45, 90112
s_nop 0
buffer_load_dwordx4 v58, s[8:11], s28 offen offset:0 lds
buffer_load_dwordx4 v59, s[8:11], s28 offen offset:1024 lds
s_add_u32 s28, s41, 1048576
s_add_u32 m0, s45, 98304
s_nop 0
buffer_load_dwordx4 v58, s[12:15], s28 offen offset:0 lds
buffer_load_dwordx4 v59, s[12:15], s28 offen offset:1024 lds
s_add_u32 s28, s41, 1048704
s_add_u32 m0, s45, 106496
s_nop 0
buffer_load_dwordx4 v58, s[12:15], s28 offen offset:0 lds
buffer_load_dwordx4 v59, s[12:15], s28 offen offset:1024 lds
s_add_u32 s28, s41, 1048576
s_add_u32 m0, s45, 114688
s_nop 0
buffer_load_dwordx4 v58, s[16:19], s28 offen offset:0 lds
buffer_load_dwordx4 v59, s[16:19], s28 offen offset:1024 lds
s_waitcnt vmcnt(20)
s_barrier
ds_read_b64_tr_b16 a[0:1], v62 offset:0
ds_read_b64_tr_b16 a[2:3], v62 offset:256
ds_read_b64_tr_b16 a[4:5], v62 offset:4096
ds_read_b64_tr_b16 a[6:7], v62 offset:4352
ds_read_b64_tr_b16 a[8:9], v62 offset:8192
ds_read_b64_tr_b16 a[10:11], v62 offset:8448
ds_read_b64_tr_b16 a[12:13], v62 offset:12288
ds_read_b64_tr_b16 a[14:15], v62 offset:12544
s_waitcnt lgkmcnt(4)
ds_read_b64_tr_b16 a[16:17], v62 offset:16384
ds_read_b64_tr_b16 a[18:19], v62 offset:16640
ds_read_b64_tr_b16 a[20:21], v62 offset:20480
ds_read_b64_tr_b16 a[22:23], v62 offset:20736
ds_read_b64_tr_b16 a[24:25], v62 offset:24576
ds_read_b64_tr_b16 a[26:27], v62 offset:24832
ds_read_b64_tr_b16 a[28:29], v62 offset:28672
ds_read_b64_tr_b16 a[30:31], v62 offset:28928
s_waitcnt lgkmcnt(4)
ds_read_b64_tr_b16 a[32:33], v62 offset:32768
ds_read_b64_tr_b16 a[34:35], v62 offset:33024
ds_read_b64_tr_b16 a[36:37], v62 offset:36864
ds_read_b64_tr_b16 a[38:39], v62 offset:37120
s_waitcnt lgkmcnt(0)
s_barrier
s_add_u32 s28, s41, 1572864
s_add_u32 m0, s45, 0
s_nop 0
buffer_load_dwordx4 v58, s[8:11], s28 offen offset:0 lds
buffer_load_dwordx4 v59, s[8:11], s28 offen offset:1024 lds
s_add_u32 s28, s41, 1572992
s_add_u32 m0, s45, 8192
s_nop 0
buffer_load_dwordx4 v58, s[8:11], s28 offen offset:0 lds
buffer_load_dwordx4 v59, s[8:11], s28 offen offset:1024 lds
s_add_u32 s28, s41, 1572864
s_add_u32 m0, s45, 16384
s_nop 0
buffer_load_dwordx4 v58, s[12:15], s28 offen offset:0 lds
buffer_load_dwordx4 v59, s[12:15], s28 offen offset:1024 lds
s_add_u32 s28, s41, 1572992
s_add_u32 m0, s45, 24576
s_nop 0
buffer_load_dwordx4 v58, s[12:15], s28 offen offset:0 lds
buffer_load_dwordx4 v59, s[12:15], s28 offen offset:1024 lds
s_add_u32 s28, s41, 1572864
s_add_u32 m0, s45, 32768
s_nop 0
buffer_load_dwordx4 v58, s[16:19], s28 offen offset:0 lds
buffer_load_dwordx4 v59, s[16:19], s28 offen offset:1024 lds
s_waitcnt vmcnt(20)
s_barrier
ds_read_b64_tr_b16 a[40:41], v62 offset:40960
ds_read_b64_tr_b16 a[42:43], v62 offset:41216
ds_read_b64_tr_b16 a[44:45], v62 offset:45056
ds_read_b64_tr_b16 a[46:47], v62 offset:45312
ds_read_b64_tr_b16 a[48:49], v62 offset:49152
ds_read_b64_tr_b16 a[50:51], v62 offset:49408
ds_read_b64_tr_b16 a[52:53], v62 offset:53248
ds_read_b64_tr_b16 a[54:55], v62 offset:53504
s_waitcnt lgkmcnt(4)
ds_read_b64_tr_b16 a[56:57], v62 offset:57344
ds_read_b64_tr_b16 a[58:59], v62 offset:57600
ds_read_b64_tr_b16 a[60:61], v62 offset:61440
ds_read_b64_tr_b16 a[62:63], v62 offset:61696
ds_read_b64_tr_b16 a[64:65], v63 offset:0
ds_read_b64_tr_b16 a[66:67], v63 offset:256
ds_read_b64_tr_b16 a[68:69], v63 offset:4096
ds_read_b64_tr_b16 a[70:71], v63 offset:4352
s_waitcnt lgkmcnt(4)
ds_read_b64_tr_b16 a[72:73], v63 offset:8192
ds_read_b64_tr_b16 a[74:75], v63 offset:8448
ds_read_b64_tr_b16 a[76:77], v63 offset:12288
ds_read_b64_tr_b16 a[78:79], v63 offset:12544
s_waitcnt lgkmcnt(0)
s_barrier
s_add_u32 s28, s41, 2097152
s_add_u32 m0, s45, 40960
s_nop 0
buffer_load_dwordx4 v58, s[8:11], s28 offen offset:0 lds
buffer_load_dwordx4 v59, s[8:11], s28 offen offset:1024 lds
s_add_u32 s28, s41, 2097280
s_add_u32 m0, s45, 49152
s_nop 0
buffer_load_dwordx4 v58, s[8:11], s28 offen offset:0 lds
buffer_load_dwordx4 v59, s[8:11], s28 offen offset:1024 lds
s_add_u32 s28, s41, 2097152
s_add_u32 m0, s45, 57344
s_nop 0
buffer_load_dwordx4 v58, s[12:15], s28 offen offset:0 lds
buffer_load_dwordx4 v59, s[12:15], s28 offen offset:1024 lds
s_add_u32 s28, s41, 2097280
s_add_u32 m0, s45, 65536
s_nop 0
buffer_load_dwordx4 v58, s[12:15], s28 offen offset:0 lds
buffer_load_dwordx4 v59, s[12:15], s28 offen offset:1024 lds
s_add_u32 s28, s41, 2097152
s_add_u32 m0, s45, 73728
s_nop 0
buffer_load_dwordx4 v58, s[16:19], s28 offen offset:0 lds
buffer_load_dwordx4 v59, s[16:19], s28 offen offset:1024 lds
s_waitcnt vmcnt(20)
s_barrier
ds_read_b64_tr_b16 a[80:81], v63 offset:16384
ds_read_b64_tr_b16 a[82:83], v63 offset:16640
ds_read_b64_tr_b16 a[84:85], v63 offset:20480
ds_read_b64_tr_b16 a[86:87], v63 offset:20736
ds_read_b64_tr_b16 a[88:89], v63 offset:24576
ds_read_b64_tr_b16 a[90:91], v63 offset:24832
ds_read_b64_tr_b16 a[92:93], v63 offset:28672
ds_read_b64_tr_b16 a[94:95], v63 offset:28928
s_waitcnt lgkmcnt(4)
ds_read_b64_tr_b16 a[96:97], v63 offset:32768
ds_read_b64_tr_b16 a[98:99], v63 offset:33024
ds_read_b64_tr_b16 a[100:101], v63 offset:36864
ds_read_b64_tr_b16 a[102:103], v63 offset:37120
ds_read_b64_tr_b16 a[104:105], v63 offset:40960
ds_read_b64_tr_b16 a[106:107], v63 offset:41216
ds_read_b64_tr_b16 a[108:109], v63 offset:45056
ds_read_b64_tr_b16 a[110:111], v63 offset:45312
s_waitcnt lgkmcnt(4)
ds_read_b64_tr_b16 a[112:113], v63 offset:49152
ds_read_b64_tr_b16 a[114:115], v63 offset:49408
ds_read_b64_tr_b16 a[116:117], v63 offset:53248
ds_read_b64_tr_b16 a[118:119], v63 offset:53504
s_waitcnt lgkmcnt(0)
s_barrier
s_add_u32 s28, s42, 0
s_add_u32 m0, s45, 81920
s_nop 0
buffer_load_dwordx4 v58, s[8:11], s28 offen offset:0 lds
buffer_load_dwordx4 v59, s[8:11], s28 offen offset:1024 lds
s_add_u32 s28, s42, 128
s_add_u32 m0, s45, 90112
s_nop 0
buffer_load_dwordx4 v58, s[8:11], s28 offen offset:0 lds
buffer_load_dwordx4 v59, s[8:11], s28 offen offset:1024 lds
s_add_u32 s28, s42, 0
s_add_u32 m0, s45, 98304
s_nop 0
buffer_load_dwordx4 v58, s[12:15], s28 offen offset:0 lds
buffer_load_dwordx4 v59, s[12:15], s28 offen offset:1024 lds
s_add_u32 s28, s42, 128
s_add_u32 m0, s45, 106496
s_nop 0
buffer_load_dwordx4 v58, s[12:15], s28 offen offset:0 lds
buffer_load_dwordx4 v59, s[12:15], s28 offen offset:1024 lds
s_add_u32 s28, s42, 524288
s_add_u32 m0, s45, 114688
s_nop 0
buffer_load_dwordx4 v58, s[8:11], s28 offen offset:0 lds
buffer_load_dwordx4 v59, s[8:11], s28 offen offset:1024 lds
s_waitcnt vmcnt(20)
s_barrier
ds_read_b64_tr_b16 a[120:121], v62 offset:0
ds_read_b64_tr_b16 a[122:123], v62 offset:256
ds_read_b64_tr_b16 a[124:125], v62 offset:4096
ds_read_b64_tr_b16 a[126:127], v62 offset:4352
ds_read_b64_tr_b16 a[128:129], v62 offset:8192
ds_read_b64_tr_b16 a[130:131], v62 offset:8448
ds_read_b64_tr_b16 a[132:133], v62 offset:12288
ds_read_b64_tr_b16 a[134:135], v62 offset:12544
s_waitcnt lgkmcnt(4)
ds_read_b64_tr_b16 a[136:137], v62 offset:16384
ds_read_b64_tr_b16 a[138:139], v62 offset:16640
ds_read_b64_tr_b16 a[140:141], v62 offset:20480
ds_read_b64_tr_b16 a[142:143], v62 offset:20736
ds_read_b64_tr_b16 a[144:145], v62 offset:24576
ds_read_b64_tr_b16 a[146:147], v62 offset:24832
ds_read_b64_tr_b16 a[148:149], v62 offset:28672
ds_read_b64_tr_b16 a[150:151], v62 offset:28928
s_waitcnt lgkmcnt(4)
ds_read_b64_tr_b16 a[152:153], v62 offset:32768
ds_read_b64_tr_b16 a[154:155], v62 offset:33024
ds_read_b64_tr_b16 a[156:157], v62 offset:36864
ds_read_b64_tr_b16 a[158:159], v62 offset:37120
s_waitcnt lgkmcnt(0)
s_barrier
s_add_u32 s28, s42, 524416
s_add_u32 m0, s45, 0
s_nop 0
buffer_load_dwordx4 v58, s[8:11], s28 offen offset:0 lds
buffer_load_dwordx4 v59, s[8:11], s28 offen offset:1024 lds
s_add_u32 s28, s42, 524288
s_add_u32 m0, s45, 8192
s_nop 0
buffer_load_dwordx4 v58, s[12:15], s28 offen offset:0 lds
buffer_load_dwordx4 v59, s[12:15], s28 offen offset:1024 lds
s_add_u32 s28, s42, 524416
s_add_u32 m0, s45, 16384
s_nop 0
buffer_load_dwordx4 v58, s[12:15], s28 offen offset:0 lds
buffer_load_dwordx4 v59, s[12:15], s28 offen offset:1024 lds
s_add_u32 s28, s42, 1048576
s_add_u32 m0, s45, 24576
s_nop 0
buffer_load_dwordx4 v58, s[8:11], s28 offen offset:0 lds
buffer_load_dwordx4 v59, s[8:11], s28 offen offset:1024 lds
s_add_u32 s28, s42, 1048704
s_add_u32 m0, s45, 32768
s_nop 0
buffer_load_dwordx4 v58, s[8:11], s28 offen offset:0 lds
buffer_load_dwordx4 v59, s[8:11], s28 offen offset:1024 lds
s_waitcnt vmcnt(20)
s_barrier
ds_read_b64_tr_b16 a[160:161], v62 offset:40960
ds_read_b64_tr_b16 a[162:163], v62 offset:41216
ds_read_b64_tr_b16 a[164:165], v62 offset:45056
ds_read_b64_tr_b16 a[166:167], v62 offset:45312
ds_read_b64_tr_b16 a[168:169], v62 offset:49152
ds_read_b64_tr_b16 a[170:171], v62 offset:49408
ds_read_b64_tr_b16 a[172:173], v62 offset:53248
ds_read_b64_tr_b16 a[174:175], v62 offset:53504
s_waitcnt lgkmcnt(4)
ds_read_b64_tr_b16 a[176:177], v62 offset:57344
ds_read_b64_tr_b16 a[178:179], v62 offset:57600
ds_read_b64_tr_b16 a[180:181], v62 offset:61440
ds_read_b64_tr_b16 a[182:183], v62 offset:61696
ds_read_b64_tr_b16 a[184:185], v63 offset:0
ds_read_b64_tr_b16 a[186:187], v63 offset:256
ds_read_b64_tr_b16 a[188:189], v63 offset:4096
ds_read_b64_tr_b16 a[190:191], v63 offset:4352
s_waitcnt lgkmcnt(4)
ds_read_b64_tr_b16 a[192:193], v63 offset:8192
ds_read_b64_tr_b16 a[194:195], v63 offset:8448
ds_read_b64_tr_b16 a[196:197], v63 offset:12288
ds_read_b64_tr_b16 a[198:199], v63 offset:12544
s_waitcnt lgkmcnt(0)
s_barrier
s_add_u32 s28, s42, 1048576
s_add_u32 m0, s45, 40960
s_nop 0
buffer_load_dwordx4 v58, s[12:15], s28 offen offset:0 lds
buffer_load_dwordx4 v59, s[12:15], s28 offen offset:1024 lds
s_add_u32 s28, s42, 1048704
s_add_u32 m0, s45, 49152
s_nop 0
buffer_load_dwordx4 v58, s[12:15], s28 offen offset:0 lds
buffer_load_dwordx4 v59, s[12:15], s28 offen offset:1024 lds
s_add_u32 s28, s42, 1572864
s_add_u32 m0, s45, 57344
s_nop 0
buffer_load_dwordx4 v58, s[8:11], s28 offen offset:0 lds
buffer_load_dwordx4 v59, s[8:11], s28 offen offset:1024 lds
s_add_u32 s28, s42, 1572992
s_add_u32 m0, s45, 65536
s_nop 0
buffer_load_dwordx4 v58, s[8:11], s28 offen offset:0 lds
buffer_load_dwordx4 v59, s[8:11], s28 offen offset:1024 lds
s_add_u32 s28, s42, 1572864
s_add_u32 m0, s45, 73728
s_nop 0
buffer_load_dwordx4 v58, s[12:15], s28 offen offset:0 lds
buffer_load_dwordx4 v59, s[12:15], s28 offen offset:1024 lds
s_waitcnt vmcnt(20)
s_barrier
ds_read_b64_tr_b16 a[200:201], v63 offset:16384
ds_read_b64_tr_b16 a[202:203], v63 offset:16640
ds_read_b64_tr_b16 a[204:205], v63 offset:20480
ds_read_b64_tr_b16 a[206:207], v63 offset:20736
ds_read_b64_tr_b16 a[208:209], v63 offset:24576
ds_read_b64_tr_b16 a[210:211], v63 offset:24832
ds_read_b64_tr_b16 a[212:213], v63 offset:28672
ds_read_b64_tr_b16 a[214:215], v63 offset:28928
s_waitcnt lgkmcnt(4)
ds_read_b64_tr_b16 a[216:217], v63 offset:32768
ds_read_b64_tr_b16 a[218:219], v63 offset:33024
ds_read_b64_tr_b16 a[220:221], v63 offset:36864
ds_read_b64_tr_b16 a[222:223], v63 offset:37120
ds_read_b64_tr_b16 a[224:225], v63 offset:40960
ds_read_b64_tr_b16 a[226:227], v63 offset:41216
ds_read_b64_tr_b16 a[228:229], v63 offset:45056
ds_read_b64_tr_b16 a[230:231], v63 offset:45312
s_waitcnt lgkmcnt(4)
ds_read_b64_tr_b16 a[232:233], v63 offset:49152
ds_read_b64_tr_b16 a[234:235], v63 offset:49408
ds_read_b64_tr_b16 a[236:237], v63 offset:53248
ds_read_b64_tr_b16 a[238:239], v63 offset:53504
s_waitcnt lgkmcnt(0)
s_barrier
s_add_u32 s28, s42, 1572992
s_add_u32 m0, s45, 81920
s_nop 0
buffer_load_dwordx4 v58, s[12:15], s28 offen offset:0 lds
buffer_load_dwordx4 v59, s[12:15], s28 offen offset:1024 lds
s_add_u32 s28, s42, 2097152
s_add_u32 m0, s45, 90112
s_nop 0
buffer_load_dwordx4 v58, s[8:11], s28 offen offset:0 lds
buffer_load_dwordx4 v59, s[8:11], s28 offen offset:1024 lds
s_add_u32 s28, s42, 2097280
s_add_u32 m0, s45, 98304
s_nop 0
buffer_load_dwordx4 v58, s[8:11], s28 offen offset:0 lds
buffer_load_dwordx4 v59, s[8:11], s28 offen offset:1024 lds
s_add_u32 s28, s42, 2097152
s_add_u32 m0, s45, 106496
s_nop 0
buffer_load_dwordx4 v58, s[12:15], s28 offen offset:0 lds
buffer_load_dwordx4 v59, s[12:15], s28 offen offset:1024 lds
s_add_u32 s28, s42, 2097280
s_add_u32 m0, s45, 114688
s_nop 0
buffer_load_dwordx4 v58, s[12:15], s28 offen offset:0 lds
buffer_load_dwordx4 v59, s[12:15], s28 offen offset:1024 lds
s_waitcnt vmcnt(20)
s_barrier
ds_read_b64_tr_b16 a[240:241], v62 offset:0
ds_read_b64_tr_b16 a[242:243], v62 offset:256
ds_read_b64_tr_b16 a[244:245], v62 offset:4096
ds_read_b64_tr_b16 a[246:247], v62 offset:4352
ds_read_b64_tr_b16 a[248:249], v62 offset:8192
ds_read_b64_tr_b16 a[250:251], v62 offset:8448
ds_read_b64_tr_b16 a[252:253], v62 offset:12288
ds_read_b64_tr_b16 a[254:255], v62 offset:12544
s_waitcnt lgkmcnt(4)
ds_read_b64_tr_b16 v[72:73], v62 offset:16384
ds_read_b64_tr_b16 v[74:75], v62 offset:16640
ds_read_b64_tr_b16 v[76:77], v62 offset:20480
ds_read_b64_tr_b16 v[78:79], v62 offset:20736
ds_read_b64_tr_b16 v[80:81], v62 offset:24576
ds_read_b64_tr_b16 v[82:83], v62 offset:24832
ds_read_b64_tr_b16 v[84:85], v62 offset:28672
ds_read_b64_tr_b16 v[86:87], v62 offset:28928
s_waitcnt lgkmcnt(4)
ds_read_b64_tr_b16 v[88:89], v62 offset:32768
ds_read_b64_tr_b16 v[90:91], v62 offset:33024
ds_read_b64_tr_b16 v[92:93], v62 offset:36864
ds_read_b64_tr_b16 v[94:95], v62 offset:37120
s_waitcnt lgkmcnt(0)
s_barrier
s_add_u32 s28, s43, 0
s_add_u32 m0, s45, 0
s_nop 0
buffer_load_dwordx4 v60, s[20:23], s28 offen offset:0 lds
buffer_load_dwordx4 v61, s[20:23], s28 offen offset:1024 lds
s_add_u32 s28, s43, 128
s_add_u32 m0, s45, 8192
s_nop 0
buffer_load_dwordx4 v60, s[20:23], s28 offen offset:0 lds
buffer_load_dwordx4 v61, s[20:23], s28 offen offset:1024 lds
s_add_u32 s28, s43, 256
s_add_u32 m0, s45, 16384
s_nop 0
buffer_load_dwordx4 v60, s[20:23], s28 offen offset:0 lds
buffer_load_dwordx4 v61, s[20:23], s28 offen offset:1024 lds
s_add_u32 s28, s43, 384
s_add_u32 m0, s45, 24576
s_nop 0
buffer_load_dwordx4 v60, s[20:23], s28 offen offset:0 lds
buffer_load_dwordx4 v61, s[20:23], s28 offen offset:1024 lds
s_add_u32 s28, s43, 512
s_add_u32 m0, s45, 32768
s_nop 0
buffer_load_dwordx4 v60, s[20:23], s28 offen offset:0 lds
buffer_load_dwordx4 v61, s[20:23], s28 offen offset:1024 lds
s_waitcnt vmcnt(20)
s_barrier
ds_read_b64_tr_b16 v[96:97], v62 offset:40960
ds_read_b64_tr_b16 v[98:99], v62 offset:41216
ds_read_b64_tr_b16 v[100:101], v62 offset:45056
ds_read_b64_tr_b16 v[102:103], v62 offset:45312
ds_read_b64_tr_b16 v[104:105], v62 offset:49152
ds_read_b64_tr_b16 v[106:107], v62 offset:49408
ds_read_b64_tr_b16 v[108:109], v62 offset:53248
ds_read_b64_tr_b16 v[110:111], v62 offset:53504
s_waitcnt lgkmcnt(4)
ds_read_b64_tr_b16 v[112:113], v62 offset:57344
ds_read_b64_tr_b16 v[114:115], v62 offset:57600
ds_read_b64_tr_b16 v[116:117], v62 offset:61440
ds_read_b64_tr_b16 v[118:119], v62 offset:61696
ds_read_b64_tr_b16 v[120:121], v63 offset:0
ds_read_b64_tr_b16 v[122:123], v63 offset:256
ds_read_b64_tr_b16 v[124:125], v63 offset:4096
ds_read_b64_tr_b16 v[126:127], v63 offset:4352
s_waitcnt lgkmcnt(4)
ds_read_b64_tr_b16 v[128:129], v63 offset:8192
ds_read_b64_tr_b16 v[130:131], v63 offset:8448
ds_read_b64_tr_b16 v[132:133], v63 offset:12288
ds_read_b64_tr_b16 v[134:135], v63 offset:12544
s_waitcnt lgkmcnt(0)
s_barrier
s_add_u32 s28, s43, 81920
s_add_u32 m0, s45, 40960
s_nop 0
buffer_load_dwordx4 v60, s[20:23], s28 offen offset:0 lds
buffer_load_dwordx4 v61, s[20:23], s28 offen offset:1024 lds
s_add_u32 s28, s43, 82048
s_add_u32 m0, s45, 49152
s_nop 0
buffer_load_dwordx4 v60, s[20:23], s28 offen offset:0 lds
buffer_load_dwordx4 v61, s[20:23], s28 offen offset:1024 lds
s_add_u32 s28, s43, 82176
s_add_u32 m0, s45, 57344
s_nop 0
buffer_load_dwordx4 v60, s[20:23], s28 offen offset:0 lds
buffer_load_dwordx4 v61, s[20:23], s28 offen offset:1024 lds
s_add_u32 s28, s43, 82304
s_add_u32 m0, s45, 65536
s_nop 0
buffer_load_dwordx4 v60, s[20:23], s28 offen offset:0 lds
buffer_load_dwordx4 v61, s[20:23], s28 offen offset:1024 lds
s_add_u32 s28, s43, 82432
s_add_u32 m0, s45, 73728
s_nop 0
buffer_load_dwordx4 v60, s[20:23], s28 offen offset:0 lds
buffer_load_dwordx4 v61, s[20:23], s28 offen offset:1024 lds
s_waitcnt vmcnt(20)
s_barrier
ds_read_b64_tr_b16 v[136:137], v63 offset:16384
ds_read_b64_tr_b16 v[138:139], v63 offset:16640
ds_read_b64_tr_b16 v[140:141], v63 offset:20480
ds_read_b64_tr_b16 v[142:143], v63 offset:20736
ds_read_b64_tr_b16 v[144:145], v63 offset:24576
ds_read_b64_tr_b16 v[146:147], v63 offset:24832
ds_read_b64_tr_b16 v[148:149], v63 offset:28672
ds_read_b64_tr_b16 v[150:151], v63 offset:28928
s_waitcnt lgkmcnt(4)
ds_read_b64_tr_b16 v[152:153], v63 offset:32768
ds_read_b64_tr_b16 v[154:155], v63 offset:33024
ds_read_b64_tr_b16 v[156:157], v63 offset:36864
ds_read_b64_tr_b16 v[158:159], v63 offset:37120
ds_read_b64_tr_b16 v[160:161], v63 offset:40960
ds_read_b64_tr_b16 v[162:163], v63 offset:41216
ds_read_b64_tr_b16 v[164:165], v63 offset:45056
ds_read_b64_tr_b16 v[166:167], v63 offset:45312
s_waitcnt lgkmcnt(4)
ds_read_b64_tr_b16 v[168:169], v63 offset:49152
ds_read_b64_tr_b16 v[170:171], v63 offset:49408
ds_read_b64_tr_b16 v[172:173], v63 offset:53248
ds_read_b64_tr_b16 v[174:175], v63 offset:53504
s_waitcnt lgkmcnt(0)
s_barrier
s_add_u32 s28, s42, 1048704
s_add_u32 m0, s45, 81920
s_nop 0
buffer_load_dwordx4 v58, s[16:19], s28 offen offset:0 lds
buffer_load_dwordx4 v59, s[16:19], s28 offen offset:1024 lds
s_add_u32 s28, s42, 1572864
s_add_u32 m0, s45, 90112
s_nop 0
buffer_load_dwordx4 v58, s[16:19], s28 offen offset:0 lds
buffer_load_dwordx4 v59, s[16:19], s28 offen offset:1024 lds
s_add_u32 s28, s42, 1572992
s_add_u32 m0, s45, 98304
s_nop 0
buffer_load_dwordx4 v58, s[16:19], s28 offen offset:0 lds
buffer_load_dwordx4 v59, s[16:19], s28 offen offset:1024 lds
s_add_u32 s28, s42, 2097152
s_add_u32 m0, s45, 106496
s_nop 0
buffer_load_dwordx4 v58, s[16:19], s28 offen offset:0 lds
buffer_load_dwordx4 v59, s[16:19], s28 offen offset:1024 lds
s_add_u32 s28, s42, 2097280
s_add_u32 m0, s45, 114688
s_nop 0
buffer_load_dwordx4 v58, s[16:19], s28 offen offset:0 lds
buffer_load_dwordx4 v59, s[16:19], s28 offen offset:1024 lds
s_waitcnt vmcnt(20)
s_barrier
ds_read_b64_tr_b16 v[176:177], v62 offset:0
ds_read_b64_tr_b16 v[178:179], v62 offset:256
ds_read_b64_tr_b16 v[180:181], v62 offset:4096
ds_read_b64_tr_b16 v[182:183], v62 offset:4352
ds_read_b64_tr_b16 v[184:185], v62 offset:8192
ds_read_b64_tr_b16 v[186:187], v62 offset:8448
ds_read_b64_tr_b16 v[188:189], v62 offset:12288
ds_read_b64_tr_b16 v[190:191], v62 offset:12544
s_waitcnt lgkmcnt(4)
ds_read_b64_tr_b16 v[192:193], v62 offset:16384
ds_read_b64_tr_b16 v[194:195], v62 offset:16640
ds_read_b64_tr_b16 v[196:197], v62 offset:20480
ds_read_b64_tr_b16 v[198:199], v62 offset:20736
ds_read_b64_tr_b16 v[200:201], v62 offset:24576
ds_read_b64_tr_b16 v[202:203], v62 offset:24832
ds_read_b64_tr_b16 v[204:205], v62 offset:28672
ds_read_b64_tr_b16 v[206:207], v62 offset:28928
s_waitcnt lgkmcnt(4)
ds_read_b64_tr_b16 v[208:209], v62 offset:32768
ds_read_b64_tr_b16 v[210:211], v62 offset:33024
ds_read_b64_tr_b16 v[212:213], v62 offset:36864
ds_read_b64_tr_b16 v[214:215], v62 offset:37120
s_waitcnt lgkmcnt(0)
s_barrier
s_add_u32 s28, s41, 128
s_add_u32 m0, s45, 0
s_nop 0
buffer_load_dwordx4 v58, s[16:19], s28 offen offset:0 lds
buffer_load_dwordx4 v59, s[16:19], s28 offen offset:1024 lds
s_add_u32 s28, s41, 524416
s_add_u32 m0, s45, 8192
s_nop 0
buffer_load_dwordx4 v58, s[16:19], s28 offen offset:0 lds
buffer_load_dwordx4 v59, s[16:19], s28 offen offset:1024 lds
s_add_u32 s28, s41, 1048704
s_add_u32 m0, s45, 16384
s_nop 0
buffer_load_dwordx4 v58, s[16:19], s28 offen offset:0 lds
buffer_load_dwordx4 v59, s[16:19], s28 offen offset:1024 lds
s_add_u32 s28, s41, 1572992
s_add_u32 m0, s45, 24576
s_nop 0
buffer_load_dwordx4 v58, s[16:19], s28 offen offset:0 lds
buffer_load_dwordx4 v59, s[16:19], s28 offen offset:1024 lds
s_add_u32 s28, s41, 2097280
s_add_u32 m0, s45, 32768
s_nop 0
buffer_load_dwordx4 v58, s[16:19], s28 offen offset:0 lds
buffer_load_dwordx4 v59, s[16:19], s28 offen offset:1024 lds
s_waitcnt vmcnt(20)
s_barrier
ds_read_b64_tr_b16 v[216:217], v62 offset:40960
ds_read_b64_tr_b16 v[218:219], v62 offset:41216
ds_read_b64_tr_b16 v[220:221], v62 offset:45056
ds_read_b64_tr_b16 v[222:223], v62 offset:45312
ds_read_b64_tr_b16 v[224:225], v62 offset:49152
ds_read_b64_tr_b16 v[226:227], v62 offset:49408
ds_read_b64_tr_b16 v[228:229], v62 offset:53248
ds_read_b64_tr_b16 v[230:231], v62 offset:53504
s_waitcnt lgkmcnt(4)
ds_read_b64_tr_b16 v[232:233], v62 offset:57344
ds_read_b64_tr_b16 v[234:235], v62 offset:57600
ds_read_b64_tr_b16 v[236:237], v62 offset:61440
ds_read_b64_tr_b16 v[238:239], v62 offset:61696
ds_read_b64_tr_b16 v[240:241], v63 offset:0
ds_read_b64_tr_b16 v[242:243], v63 offset:256
ds_read_b64_tr_b16 v[244:245], v63 offset:4096
ds_read_b64_tr_b16 v[246:247], v63 offset:4352
s_waitcnt lgkmcnt(4)
ds_read_b64_tr_b16 v[248:249], v63 offset:8192
ds_read_b64_tr_b16 v[250:251], v63 offset:8448
ds_read_b64_tr_b16 v[252:253], v63 offset:12288
ds_read_b64_tr_b16 v[254:255], v63 offset:12544
s_waitcnt lgkmcnt(0)
s_barrier
s_add_u32 s28, s42, 0
s_add_u32 m0, s45, 40960
s_nop 0
buffer_load_dwordx4 v58, s[16:19], s28 offen offset:0 lds
buffer_load_dwordx4 v59, s[16:19], s28 offen offset:1024 lds
s_add_u32 s28, s42, 128
s_add_u32 m0, s45, 49152
s_nop 0
buffer_load_dwordx4 v58, s[16:19], s28 offen offset:0 lds
buffer_load_dwordx4 v59, s[16:19], s28 offen offset:1024 lds
s_add_u32 s28, s42, 524288
s_add_u32 m0, s45, 57344
s_nop 0
buffer_load_dwordx4 v58, s[16:19], s28 offen offset:0 lds
buffer_load_dwordx4 v59, s[16:19], s28 offen offset:1024 lds
s_add_u32 s28, s42, 524416
s_add_u32 m0, s45, 65536
s_nop 0
buffer_load_dwordx4 v58, s[16:19], s28 offen offset:0 lds
buffer_load_dwordx4 v59, s[16:19], s28 offen offset:1024 lds
s_add_u32 s28, s42, 1048576
s_add_u32 m0, s45, 73728
s_nop 0
buffer_load_dwordx4 v58, s[16:19], s28 offen offset:0 lds
buffer_load_dwordx4 v59, s[16:19], s28 offen offset:1024 lds
s_waitcnt vmcnt(20)
s_barrier
ds_read_b64_tr_b16 v[8:9], v63 offset:16384
ds_read_b64_tr_b16 v[10:11], v63 offset:16640
ds_read_b64_tr_b16 v[12:13], v63 offset:20480
ds_read_b64_tr_b16 v[14:15], v63 offset:20736
ds_read_b64_tr_b16 v[16:17], v63 offset:24576
ds_read_b64_tr_b16 v[18:19], v63 offset:24832
ds_read_b64_tr_b16 v[20:21], v63 offset:28672
ds_read_b64_tr_b16 v[22:23], v63 offset:28928
s_waitcnt lgkmcnt(4)
ds_read_b64_tr_b16 v[24:25], v63 offset:32768
ds_read_b64_tr_b16 v[26:27], v63 offset:33024
ds_read_b64_tr_b16 v[28:29], v63 offset:36864
ds_read_b64_tr_b16 v[30:31], v63 offset:37120
ds_read_b64_tr_b16 v[32:33], v63 offset:40960
ds_read_b64_tr_b16 v[34:35], v63 offset:41216
ds_read_b64_tr_b16 v[36:37], v63 offset:45056
ds_read_b64_tr_b16 v[38:39], v63 offset:45312
s_waitcnt lgkmcnt(4)
ds_read_b64_tr_b16 v[40:41], v63 offset:49152
ds_read_b64_tr_b16 v[42:43], v63 offset:49408
ds_read_b64_tr_b16 v[44:45], v63 offset:53248
ds_read_b64_tr_b16 v[46:47], v63 offset:53504
s_waitcnt lgkmcnt(0)
s_barrier
ds_write_b128 v65, v[8:11] offset:16384
ds_write_b128 v65, v[12:15] offset:17408
ds_write_b128 v65, v[16:19] offset:24576
ds_write_b128 v65, v[20:23] offset:25600
ds_write_b128 v65, v[24:27] offset:32768
ds_write_b128 v65, v[28:31] offset:33792
ds_write_b128 v65, v[32:35] offset:40960
ds_write_b128 v65, v[36:39] offset:41984
ds_write_b128 v65, v[40:43] offset:49152
ds_write_b128 v65, v[44:47] offset:50176
s_waitcnt lgkmcnt(0)
s_waitcnt vmcnt(10)
s_barrier
ds_read_b64_tr_b16 v[8:9], v62 offset:0
ds_read_b64_tr_b16 v[10:11], v62 offset:256
ds_read_b64_tr_b16 v[12:13], v62 offset:4096
ds_read_b64_tr_b16 v[14:15], v62 offset:4352
ds_read_b64_tr_b16 v[16:17], v62 offset:8192
ds_read_b64_tr_b16 v[18:19], v62 offset:8448
ds_read_b64_tr_b16 v[20:21], v62 offset:12288
ds_read_b64_tr_b16 v[22:23], v62 offset:12544
s_waitcnt lgkmcnt(4)
ds_read_b64_tr_b16 v[24:25], v62 offset:16384
ds_read_b64_tr_b16 v[26:27], v62 offset:16640
ds_read_b64_tr_b16 v[28:29], v62 offset:20480
ds_read_b64_tr_b16 v[30:31], v62 offset:20736
ds_read_b64_tr_b16 v[32:33], v62 offset:24576
ds_read_b64_tr_b16 v[34:35], v62 offset:24832
ds_read_b64_tr_b16 v[36:37], v62 offset:28672
ds_read_b64_tr_b16 v[38:39], v62 offset:28928
s_waitcnt lgkmcnt(4)
ds_read_b64_tr_b16 v[40:41], v62 offset:32768
ds_read_b64_tr_b16 v[42:43], v62 offset:33024
ds_read_b64_tr_b16 v[44:45], v62 offset:36864
ds_read_b64_tr_b16 v[46:47], v62 offset:37120
s_waitcnt lgkmcnt(0)
s_barrier
ds_write_b128 v64, v[8:11] offset:0
ds_write_b128 v64, v[12:15] offset:1024
ds_write_b128 v64, v[16:19] offset:8192
ds_write_b128 v64, v[20:23] offset:9216
ds_write_b128 v64, v[24:27] offset:16384
ds_write_b128 v64, v[28:31] offset:17408
ds_write_b128 v64, v[32:35] offset:24576
ds_write_b128 v64, v[36:39] offset:25600
ds_write_b128 v64, v[40:43] offset:32768
ds_write_b128 v64, v[44:47] offset:33792
s_waitcnt lgkmcnt(0)
s_waitcnt vmcnt(0)
s_barrier
v_lshlrev_b32 v67, 2, v0
v_add_u32 v67, 1024, v67
buffer_load_dword v66, v67, s[4:7], 0 offen sc1
ds_read_b64_tr_b16 v[8:9], v62 offset:40960
ds_read_b64_tr_b16 v[10:11], v62 offset:41216
ds_read_b64_tr_b16 v[12:13], v62 offset:45056
ds_read_b64_tr_b16 v[14:15], v62 offset:45312
ds_read_b64_tr_b16 v[16:17], v62 offset:49152
ds_read_b64_tr_b16 v[18:19], v62 offset:49408
ds_read_b64_tr_b16 v[20:21], v62 offset:53248
ds_read_b64_tr_b16 v[22:23], v62 offset:53504
s_waitcnt lgkmcnt(4)
ds_read_b64_tr_b16 v[24:25], v62 offset:57344
ds_read_b64_tr_b16 v[26:27], v62 offset:57600
ds_read_b64_tr_b16 v[28:29], v62 offset:61440
ds_read_b64_tr_b16 v[30:31], v62 offset:61696
ds_read_b64_tr_b16 v[32:33], v63 offset:0
ds_read_b64_tr_b16 v[34:35], v63 offset:256
ds_read_b64_tr_b16 v[36:37], v63 offset:4096
ds_read_b64_tr_b16 v[38:39], v63 offset:4352
s_waitcnt lgkmcnt(4)
ds_read_b64_tr_b16 v[40:41], v63 offset:8192
ds_read_b64_tr_b16 v[42:43], v63 offset:8448
ds_read_b64_tr_b16 v[44:45], v63 offset:12288
ds_read_b64_tr_b16 v[46:47], v63 offset:12544
s_waitcnt lgkmcnt(0)
s_barrier
ds_write_b128 v64, v[8:11] offset:40960
ds_write_b128 v64, v[12:15] offset:41984
ds_write_b128 v64, v[16:19] offset:49152
ds_write_b128 v64, v[20:23] offset:50176
ds_write_b128 v64, v[24:27] offset:57344
ds_write_b128 v64, v[28:31] offset:58368
ds_write_b128 v65, v[32:35] offset:0
ds_write_b128 v65, v[36:39] offset:1024
ds_write_b128 v65, v[40:43] offset:8192
ds_write_b128 v65, v[44:47] offset:9216
s_waitcnt lgkmcnt(0)
v_and_b32 v8, 15, v0
v_lshrrev_b32 v9, 4, v0
s_lshl_b32 s28, s24, 4
v_add_u32 v2, s28, v8
v_lshlrev_b32 v2, 5, v2
v_lshl_add_u32 v2, v9, 3, v2
v_add_u32 v2, 141312, v2
v_bfe_u32 v10, v0, 2, 2
v_lshl_add_u32 v3, v9, 3, v10
v_lshlrev_b32 v3, 5, v3
v_and_b32 v10, 3, v0
v_lshl_add_u32 v3, v10, 3, v3
v_add_u32 v3, 141312, v3
v_lshrrev_b32 v10, 2, v8
v_lshrrev_b32 v12, 5, v0
v_lshl_add_u32 v10, v10, 1, v12
v_lshlrev_b32 v10, 1, v10
v_add_u32 v10, s28, v10
v_and_b32 v11, 1, v0
v_add_u32 v10, v10, v11
v_lshlrev_b32 v10, 4, v10
v_and_b32 v12, 1, v9
v_lshl_add_u32 v4, v12, 3, v10
v_add_u32 v4, 149504, v4
v_mov_b32 v1, 0x4444
v_mov_b32 v12, 0xeeee
v_bfe_u32 v11, v0, 1, 1
v_cmp_eq_u32 vcc, 1, v11
s_nop 1
v_cndmask_b32 v1, v1, v12, vcc
v_lshlrev_b32 v0, 4, v0
v_add_u32 v5, 131072, v0
s_lshl_b32 s28, s24, 11
v_add_u32 v6, s28, v0
v_add_u32 v7, 0x10000, v6
s_mov_b32 s50, 0
s_mov_b32 s51, 131072
s_mov_b32 s52, 151552
s_mov_b32 s53, 172032
s_mov_b32 s54, 0
s_lshl_b32 s28, s26, 5
s_add_u32 s28, s28, s25
s_mul_i32 s55, s28, 10240
s_lshl_b32 s29, s24, 9
s_add_u32 s55, s55, s29
s_add_u32 s55, s55, 262144
s_add_u32 s56, s55, 4096
s_add_u32 s57, s55, 8192
s_lshl_b32 s28, s26, 5
s_mul_i32 s58, s28, 10240
s_lshl_b32 s29, s25, 9
s_add_u32 s58, s58, s29
s_lshl_b32 s29, s24, 7
s_add_u32 s58, s58, s29
s_add_u32 s58, s58, 262144
s_add_u32 s32, s58, 81920
s_add_u32 s33, s58, 163840
s_add_u32 s34, s58, 245760
s_mul_i32 s59, s26, 5120
s_lshl_b32 s29, s25, 8
s_add_u32 s59, s59, s29
s_lshl_b32 s60, s25, 13
s_lshl_b32 s63, s25, 5
s_lshl_b32 s28, s26, 4
s_add_u32 s63, s63, s28
s_lshl_b32 s28, s24, 2
s_add_u32 s63, s63, s28
s_add_u32 s63, s63, 32768
s_mov_b32 s46, 0x19000
s_mov_b32 s68, 0x3e0293ee
s_mov_b32 s67, 0
s_cmp_gt_u32 s24, 1
s_cselect_b32 s47, 16777216, 0
s_add_u32 s47, s47, 4194304
s_and_b32 s28, s24, 1
s_lshl_b32 s28, s28, 12
s_add_u32 s47, s47, s28
s_add_u32 s47, s47, 262144
s_sub_u32 s28, s24, 1
s_lshl_b32 s28, s28, 11
s_cmp_eq_u32 s24, 3
s_cselect_b32 s48, 3072, s28
s_mul_i32 s61, s26, 5120
s_sub_u32 s62, 15360, s61
s_add_u32 s61, s61, s48
s_mov_b32 s49, s48
s_add_u32 s62, s62, s49
s_add_u32 s49, s49, 5120
s_add_u32 s48, s48, 131072
s_add_u32 s49, s49, 131072
s_add_u32 s70, s51, s61
s_add_u32 s71, s51, s62
v_lshrrev_b32 v8, 2, v0
v_add_u32 v8, 145408, v8
v_mov_b32 v9, -1
ds_write_b32 v8, v9
v_mov_b64 v[28:29], 0
v_mov_b64 v[30:31], 0
v_mov_b64 v[32:33], 0
v_mov_b64 v[34:35], 0
v_mov_b64 v[36:37], 0
v_mov_b64 v[38:39], 0
v_mov_b64 v[40:41], 0
v_mov_b64 v[42:43], 0
v_mov_b64 v[44:45], 0
v_mov_b64 v[46:47], 0
v_mov_b64 v[48:49], 0
v_mov_b64 v[50:51], 0
s_waitcnt vmcnt(0)
v_cmp_eq_u32 vcc, 0, v66
s_cbranch_vccz KS_62
v_mbcnt_lo_u32_b32 v9, -1, 0
v_mbcnt_hi_u32_b32 v9, -1, v9
v_lshlrev_b32 v9, 2, v9
v_add_u32 v9, 1024, v9
s_mov_b32 s28, 0
PL_63:
buffer_load_dword v8, v9, s[4:7], 0 offen sc1
s_waitcnt vmcnt(0)
v_cmp_eq_u32 vcc, 0, v8
s_cbranch_vccz PD_64
s_add_u32 s28, s28, 1
s_cmp_lt_u32 s28, 131072
s_cbranch_scc1 PL_63
v_mov_b32 v2, 10
v_mov_b32 v3, 200864
buffer_store_dword v2, v3, s[4:7], 0 offen sc1
s_waitcnt vmcnt(0)
s_endpgm
PD_64:
KS_62:
s_cmp_eq_u32 s27, 0
s_cbranch_scc1 STEP_S
STEP_F:
s_cmp_eq_u32 s24, 0
s_cbranch_scc1 Z_65
buffer_load_dwordx4 v[8:11], v0, s[4:7], s70 offen offset:0 sc1
buffer_load_dwordx4 v[12:15], v0, s[4:7], s70 offen offset:1024 sc1
GP_67:
s_waitcnt vmcnt(0)
v_max3_u32 v68, v8, v9, v10
v_max3_u32 v68, v68, v11, v12
v_max3_u32 v69, v13, v14, v15
v_max_u32 v68, v68, v69
v_cmp_eq_u32 vcc, -1, v68
s_cbranch_vccz GD_68
buffer_load_dwordx4 v[8:11], v0, s[4:7], s70 offen offset:0 sc1
buffer_load_dwordx4 v[12:15], v0, s[4:7], s70 offen offset:1024 sc1
s_add_u32 s67, s67, 1
s_cmp_lt_u32 s67, 131072
s_cbranch_scc1 GP_67
v_mov_b32 v2, 11
v_mov_b32 v3, 200864
buffer_store_dword v2, v3, s[4:7], 0 offen sc1
s_waitcnt vmcnt(0)
s_endpgm
GD_68:
v_add_u32 v68, s48, v0
ds_write_b128 v68, v[8:11]
ds_write_b128 v68, v[12:15] offset:1024
s_branch LD_66
Z_65:
s_waitcnt vmcnt(1)
LD_66:
s_waitcnt lgkmcnt(0)
s_barrier
ds_read_b128 v[8:11], v5 offset:0
ds_read_b128 v[52:55], v6 offset:0
ds_read_b128 v[56:59], v6 offset:1024
ds_read_b128 v[12:15], v5 offset:1024
ds_read_b128 v[16:19], v5 offset:2048
ds_read_b128 v[20:23], v5 offset:3072
ds_read_b128 v[24:27], v5 offset:4096
s_cmp_eq_u32 s24, 0
s_cbranch_scc1 W_69
buffer_load_dwordx4 v[60:63], v0, s[4:7], s71 offen offset:0 sc1
buffer_load_dwordx4 v[64:67], v0, s[4:7], s71 offen offset:1024 sc1
W_69:
s_waitcnt lgkmcnt(6)
v_smfmac_f32_16x16x64_bf16 v[28:31], v[8:11], a[0:7], v1
v_smfmac_f32_16x16x64_bf16 v[36:39], v[8:11], a[8:15], v1
v_smfmac_f32_16x16x64_bf16 v[32:35], v[8:11], a[16:23], v1
v_smfmac_f32_16x16x64_bf16 v[40:43], v[8:11], a[24:31], v1
v_smfmac_f32_16x16x64_bf16 v[44:47], v[8:11], a[32:39], v1
s_waitcnt lgkmcnt(4)
v_smfmac_f32_16x16x64_bf16 v[48:51], v[8:11], v[52:59], v1
ds_read_b128 v[52:55], v6 offset:8192
ds_read_b128 v[56:59], v6 offset:9216
s_lshl_b32 s65, s24, 11
s_add_u32 s64, s60, s65
s_add_u32 s64, s64, 4194304
s_add_u32 m0, s65, 151552
s_lshl_b32 s66, s24, 10
buffer_load_dwordx4 v0, s[4:7], s64 offen sc1 lds
buffer_load_dwordx4 v0, s[4:7], s64 offen offset:1024 sc1 lds
s_waitcnt lgkmcnt(5)
v_smfmac_f32_16x16x64_bf16 v[28:31], v[12:15], a[40:47], v1
v_smfmac_f32_16x16x64_bf16 v[36:39], v[12:15], a[48:55], v1
v_smfmac_f32_16x16x64_bf16 v[32:35], v[12:15], a[56:63], v1
v_smfmac_f32_16x16x64_bf16 v[40:43], v[12:15], a[64:71], v1
v_smfmac_f32_16x16x64_bf16 v[44:47], v[12:15], a[72:79], v1
s_waitcnt lgkmcnt(0)
v_smfmac_f32_16x16x64_bf16 v[48:51], v[12:15], v[52:59], v1
ds_read_b128 v[52:55], v6 offset:16384
ds_read_b128 v[56:59], v6 offset:17408
s_add_u32 s64, s60, s66
s_add_u32 s64, s64, 20971520
s_add_u32 m0, s65, 122880
s_add_u32 s66, s64, 3072
buffer_load_dwordx4 v0, s[4:7], s64 offen sc1 lds
buffer_load_dwordx4 v0, s[4:7], s66 offen offset:1024 sc1 lds
v_smfmac_f32_16x16x64_bf16 v[28:31], v[16:19], a[80:87], v1
v_smfmac_f32_16x16x64_bf16 v[36:39], v[16:19], a[88:95], v1
v_smfmac_f32_16x16x64_bf16 v[32:35], v[16:19], a[96:103], v1
v_smfmac_f32_16x16x64_bf16 v[40:43], v[16:19], a[104:111], v1
v_smfmac_f32_16x16x64_bf16 v[44:47], v[16:19], a[112:119], v1
s_waitcnt lgkmcnt(0)
v_smfmac_f32_16x16x64_bf16 v[48:51], v[16:19], v[52:59], v1
ds_read_b128 v[52:55], v6 offset:24576
ds_read_b128 v[56:59], v6 offset:25600
v_smfmac_f32_16x16x64_bf16 v[28:31], v[20:23], a[120:127], v1
v_smfmac_f32_16x16x64_bf16 v[36:39], v[20:23], a[128:135], v1
v_smfmac_f32_16x16x64_bf16 v[32:35], v[20:23], a[136:143], v1
v_smfmac_f32_16x16x64_bf16 v[40:43], v[20:23], a[144:151], v1
v_smfmac_f32_16x16x64_bf16 v[44:47], v[20:23], a[152:159], v1
s_waitcnt lgkmcnt(0)
v_smfmac_f32_16x16x64_bf16 v[48:51], v[20:23], v[52:59], v1
ds_read_b128 v[52:55], v6 offset:32768
ds_read_b128 v[56:59], v6 offset:33792
v_smfmac_f32_16x16x64_bf16 v[28:31], v[24:27], a[160:167], v1
v_smfmac_f32_16x16x64_bf16 v[36:39], v[24:27], a[168:175], v1
v_smfmac_f32_16x16x64_bf16 v[32:35], v[24:27], a[176:183], v1
v_smfmac_f32_16x16x64_bf16 v[40:43], v[24:27], a[184:191], v1
v_smfmac_f32_16x16x64_bf16 v[44:47], v[24:27], a[192:199], v1
s_waitcnt lgkmcnt(0)
v_smfmac_f32_16x16x64_bf16 v[48:51], v[24:27], v[52:59], v1
s_cmp_eq_u32 s24, 0
s_cbranch_scc1 W_70
GP_72:
s_waitcnt vmcnt(0)
v_max3_u32 v68, v60, v61, v62
v_max3_u32 v68, v68, v63, v64
v_max3_u32 v69, v65, v66, v67
v_max_u32 v68, v68, v69
v_cmp_eq_u32 vcc, -1, v68
s_cbranch_vccz GD_73
buffer_load_dwordx4 v[60:63], v0, s[4:7], s71 offen offset:0 sc1
buffer_load_dwordx4 v[64:67], v0, s[4:7], s71 offen offset:1024 sc1
s_add_u32 s67, s67, 1
s_cmp_lt_u32 s67, 131072
s_cbranch_scc1 GP_72
v_mov_b32 v2, 13
v_mov_b32 v3, 200864
buffer_store_dword v2, v3, s[4:7], 0 offen sc1
s_waitcnt vmcnt(0)
s_endpgm
GD_73:
v_add_u32 v68, s49, v0
ds_write_b128 v68, v[60:63]
ds_write_b128 v68, v[64:67] offset:1024
s_branch W_71
W_70:
s_waitcnt vmcnt(0)
W_71:
s_waitcnt lgkmcnt(0)
s_barrier
ds_read_b128 v[8:11], v5 offset:5120
ds_read_b128 v[12:15], v5 offset:6144
ds_read_b128 v[16:19], v5 offset:7168
ds_read_b128 v[20:23], v5 offset:8192
ds_read_b128 v[24:27], v5 offset:9216
ds_read_b128 v[52:55], v5 offset:20480
ds_read_b128 v[56:59], v5 offset:21504
ds_read_b128 v[60:63], v5 offset:22528
ds_read_b128 v[64:67], v5 offset:23552
buffer_store_dword v1, off, s[4:7], s46 sc1
s_waitcnt lgkmcnt(8)
v_smfmac_f32_16x16x64_bf16 v[28:31], v[8:11], a[200:207], v1
s_waitcnt lgkmcnt(7)
v_smfmac_f32_16x16x64_bf16 v[28:31], v[12:15], a[232:239], v1
s_waitcnt lgkmcnt(6)
v_smfmac_f32_16x16x64_bf16 v[28:31], v[16:19], v[80:87], v1
s_waitcnt lgkmcnt(5)
v_smfmac_f32_16x16x64_bf16 v[28:31], v[20:23], v[112:119], v1
s_waitcnt lgkmcnt(4)
v_smfmac_f32_16x16x64_bf16 v[28:31], v[24:27], v[144:151], v1
v_lshlrev_b32 v70, 2, v0
s_add_u32 s64, s60, s47
s_mov_b32 m0, 159744
v_smfmac_f32_16x16x64_bf16 v[32:35], v[8:11], a[216:223], v1
buffer_load_dword v70, s[4:7], s64 offen sc1 lds
v_smfmac_f32_16x16x64_bf16 v[32:35], v[12:15], a[248:255], v1
v_smfmac_f32_16x16x64_bf16 v[32:35], v[16:19], v[96:103], v1
v_smfmac_f32_16x16x64_bf16 v[32:35], v[20:23], v[128:135], v1
v_smfmac_f32_16x16x64_bf16 v[32:35], v[24:27], v[160:167], v1
v_pk_add_f32 v[28:29], v[28:29], v[30:31]
v_cvt_pk_bf16_f32 v68, v28, v29
v_smfmac_f32_16x16x64_bf16 v[36:39], v[8:11], a[208:215], v1
s_and_b32 s64, s50, 3
s_cmp_lg_u32 s64, 1
s_cbranch_scc1 B_74
s_lshr_b32 s64, s50, 2
s_lshl_b32 s64, s64, 8
s_add_u32 s64, s64, 1280
s_lshl_b32 s65, s24, 8
s_add_u32 m0, s65, 160768
v_lshrrev_b32 v71, 2, v0
buffer_load_dword v71, s[4:7], s64 offen sc1 lds
B_74:
v_smfmac_f32_16x16x64_bf16 v[36:39], v[12:15], a[240:247], v1
v_smfmac_f32_16x16x64_bf16 v[36:39], v[16:19], v[88:95], v1
v_pk_add_f32 v[32:33], v[32:33], v[34:35]
v_cvt_pk_bf16_f32 v69, v32, v33
ds_write_b64 v2, v[68:69]
v_smfmac_f32_16x16x64_bf16 v[36:39], v[20:23], v[120:127], v1
v_smfmac_f32_16x16x64_bf16 v[36:39], v[24:27], v[152:159], v1
v_smfmac_f32_16x16x64_bf16 v[40:43], v[8:11], a[224:231], v1
s_cmp_lg_u32 s24, 0
s_cbranch_scc1 B_75
s_cmp_ge_u32 s25, 20
s_cbranch_scc1 B_75
v_mov_b32 v70, -1
v_lshrrev_b32 v71, 2, v0
s_add_u32 s64, s53, s59
s_add_u32 s65, s64, 10240
buffer_store_dword v70, v71, s[4:7], s64 offen
buffer_store_dword v70, v71, s[4:7], s65 offen sc1
B_75:
v_smfmac_f32_16x16x64_bf16 v[40:43], v[12:15], v[72:79], v1
v_smfmac_f32_16x16x64_bf16 v[40:43], v[16:19], v[104:111], v1
v_pk_add_f32 v[36:37], v[36:37], v[38:39]
v_cvt_pk_bf16_f32 v70, v36, v37
v_smfmac_f32_16x16x64_bf16 v[40:43], v[20:23], v[136:143], v1
v_smfmac_f32_16x16x64_bf16 v[40:43], v[24:27], v[168:175], v1
s_lshr_b32 s45, s60, 1
s_lshl_b32 s64, s24, 10
s_add_u32 s45, s45, s64
s_add_u32 s45, s45, 65011712
s_nop 3
v_pk_add_f32 v[40:41], v[40:41], v[42:43]
v_cvt_pk_bf16_f32 v71, v40, v41
ds_write_b64 v2, v[70:71] offset:2048
s_waitcnt lgkmcnt(0)
s_barrier
ds_read_b64_tr_b16 v[8:9], v3 offset:0
ds_read_b64_tr_b16 v[10:11], v3 offset:128
ds_read_b64_tr_b16 v[12:13], v3 offset:1024
ds_read_b64_tr_b16 v[14:15], v3 offset:1152
ds_read_b64_tr_b16 v[16:17], v3 offset:2048
ds_read_b64_tr_b16 v[18:19], v3 offset:2176
ds_read_b64_tr_b16 v[20:21], v3 offset:3072
ds_read_b64_tr_b16 v[22:23], v3 offset:3200
s_cmp_lg_u32 s26, 0
s_cbranch_scc1 K_76
buffer_store_dwordx4 v[68:71], v0, s[4:7], s45 offen sc1
K_76:
ds_read_b128 v[24:27], v5 offset:24576
ds_read_b128 v[40:43], v5 offset:25600
ds_read_b128 v[36:39], v5 offset:26624
s_waitcnt lgkmcnt(9)
s_nop 1
v_mfma_f32_16x16x32_bf16 v[28:31], v[52:55], v[8:11], 0
v_mfma_f32_16x16x32_bf16 v[32:35], v[56:59], v[8:11], 0
v_mfma_f32_16x16x32_bf16 v[68:71], v[8:11], v[8:11], 0
ds_read_b128 v[52:55], v5 offset:27648
ds_read_b128 v[8:11], v5 offset:5120
s_waitcnt lgkmcnt(9)
v_mfma_f32_16x16x32_bf16 v[28:31], v[60:63], v[12:15], v[28:31]
v_mfma_f32_16x16x32_bf16 v[32:35], v[64:67], v[12:15], v[32:35]
v_mfma_f32_16x16x32_bf16 v[68:71], v[12:15], v[12:15], v[68:71]
ds_read_b128 v[60:63], v6 offset:40960
ds_read_b128 v[64:67], v6 offset:41984
ds_read_b128 v[12:15], v5 offset:6144
s_waitcnt lgkmcnt(6)
v_mfma_f32_16x16x32_bf16 v[28:31], v[24:27], v[16:19], v[28:31]
v_mfma_f32_16x16x32_bf16 v[32:35], v[40:43], v[16:19], v[32:35]
v_mfma_f32_16x16x32_bf16 v[68:71], v[16:19], v[16:19], v[68:71]
ds_read_b128 v[16:19], v5 offset:7168
ds_read_b128 v[24:27], v5 offset:9216
s_waitcnt lgkmcnt(6)
v_mfma_f32_16x16x32_bf16 v[28:31], v[36:39], v[20:23], v[28:31]
v_mfma_f32_16x16x32_bf16 v[32:35], v[52:55], v[20:23], v[32:35]
v_mfma_f32_16x16x32_bf16 v[68:71], v[20:23], v[20:23], v[68:71]
ds_read_b128 v[20:23], v5 offset:8192
ds_read_b128 v[36:39], v6 offset:49152
ds_read_b128 v[40:43], v6 offset:50176
ds_read_b128 v[52:55], v6 offset:57344
ds_read_b128 v[56:59], v6 offset:58368
s_waitcnt lgkmcnt(10)
s_waitcnt lgkmcnt(8)
v_smfmac_f32_16x16x64_bf16 v[44:47], v[8:11], v[60:67], v1
ds_read_b128 v[60:63], v7 offset:0
ds_read_b128 v[64:67], v7 offset:1024
v_max3_f32 v68, v28, v29, v30
v_max3_f32 v69, v31, v32, v33
v_max3_f32 v68, v68, v34, v35
v_max3_f32 v69, v69, v70, v71
v_max_f32 v68, v68, v69
v_mov_b32 v69, v68
s_waitcnt lgkmcnt(4)
v_smfmac_f32_16x16x64_bf16 v[48:51], v[8:11], v[36:43], v1
ds_read_b128 v[36:39], v7 offset:8192
ds_read_b128 v[40:43], v7 offset:9216
ds_read_b128 v[8:11], v7 offset:57344
v_permlane16_swap_b32 v68, v69
v_max_f32 v68, v68, v69
v_mov_b32 v69, v68
s_waitcnt lgkmcnt(5)
v_smfmac_f32_16x16x64_bf16 v[44:47], v[12:15], v[52:59], v1
ds_read_b128 v[52:55], v7 offset:16384
ds_read_b128 v[56:59], v7 offset:17408
v_permlane32_swap_b32 v68, v69
v_max_f32 v68, v68, v69
v_mul_f32 v68, s68, v68
v_pk_fma_f32 v[28:29], v[28:29], s[68:69], v[68:69] op_sel_hi:[1,0,0] neg_lo:[0,0,1] neg_hi:[0,0,1]
v_pk_fma_f32 v[30:31], v[30:31], s[68:69], v[68:69] op_sel_hi:[1,0,0] neg_lo:[0,0,1] neg_hi:[0,0,1]
v_pk_fma_f32 v[32:33], v[32:33], s[68:69], v[68:69] op_sel_hi:[1,0,0] neg_lo:[0,0,1] neg_hi:[0,0,1]
v_pk_fma_f32 v[34:35], v[34:35], s[68:69], v[68:69] op_sel_hi:[1,0,0] neg_lo:[0,0,1] neg_hi:[0,0,1]
v_pk_fma_f32 v[70:71], v[70:71], s[68:69], v[68:69] op_sel_hi:[1,0,0] neg_lo:[0,0,1] neg_hi:[0,0,1]
s_waitcnt lgkmcnt(5)
v_smfmac_f32_16x16x64_bf16 v[48:51], v[12:15], v[60:67], v1
ds_read_b128 v[60:63], v7 offset:24576
ds_read_b128 v[64:67], v7 offset:25600
ds_read_b128 v[12:15], v7 offset:58368
v_exp_f32 v28, v28
v_exp_f32 v29, v29
v_exp_f32 v30, v30
s_waitcnt lgkmcnt(6)
v_smfmac_f32_16x16x64_bf16 v[44:47], v[16:19], v[36:43], v1
ds_read_b128 v[36:39], v7 offset:32768
ds_read_b128 v[40:43], v7 offset:33792
v_exp_f32 v31, v31
v_exp_f32 v32, v32
s_waitcnt lgkmcnt(5)
v_smfmac_f32_16x16x64_bf16 v[48:51], v[16:19], v[52:59], v1
ds_read_b128 v[52:55], v7 offset:40960
ds_read_b128 v[56:59], v7 offset:41984
v_exp_f32 v33, v33
v_exp_f32 v34, v34
s_waitcnt lgkmcnt(5)
v_smfmac_f32_16x16x64_bf16 v[44:47], v[20:23], v[60:67], v1
ds_read_b128 v[60:63], v7 offset:49152
ds_read_b128 v[64:67], v7 offset:50176
v_exp_f32 v35, v35
v_exp_f32 v70, v70
s_waitcnt lgkmcnt(4)
v_smfmac_f32_16x16x64_bf16 v[48:51], v[20:23], v[36:43], v1
v_exp_f32 v71, v71
v_pk_add_f32 v[68:69], v[28:29], v[30:31]
v_pk_add_f32 v[68:69], v[68:69], v[32:33]
s_waitcnt lgkmcnt(2)
v_smfmac_f32_16x16x64_bf16 v[44:47], v[24:27], v[52:59], v1
v_pk_add_f32 v[68:69], v[68:69], v[34:35]
v_pk_add_f32 v[68:69], v[68:69], v[70:71]
v_cvt_pk_bf16_f32 v28, v28, v29
v_cvt_pk_bf16_f32 v29, v30, v31
s_waitcnt lgkmcnt(0)
v_smfmac_f32_16x16x64_bf16 v[48:51], v[24:27], v[60:67], v1
v_cvt_pk_bf16_f32 v30, v32, v33
v_cvt_pk_bf16_f32 v31, v34, v35
v_cvt_pk_bf16_f32 v32, v70, v71
v_mov_b64 v[34:35], 0
v_add_f32 v68, v68, v69
v_mfma_f32_16x16x32_bf16 v[16:19], v[8:11], v[28:31], 0
v_mfma_f32_16x16x32_bf16 v[20:23], v[12:15], v[28:31], 0
v_mov_b32 v33, 0
v_mov_b32 v35, v32
v_mov_b32 v69, v68
v_lshrrev_b32 v24, 1, v0
s_nop 0
v_permlane16_swap_b32 v68, v69
v_pk_add_f32 v[44:45], v[44:45], v[46:47]
v_pk_add_f32 v[48:49], v[48:49], v[50:51]
v_add_f32 v68, v68, v69
v_cvt_pk_bf16_f32 v44, v44, v45
v_cvt_pk_bf16_f32 v45, v48, v49
v_mov_b32 v69, v68
v_mov_b64 v[52:53], 0
v_mfma_f32_16x16x16_bf16 v[16:19], v[44:45], v[32:33], v[16:19]
v_mfma_f32_16x16x16_bf16 v[20:23], v[44:45], v[34:35], v[20:23]
v_permlane32_swap_b32 v68, v69
v_add_f32 v68, v68, v69
v_rcp_f32 v68, v68
s_cmp_lg_u32 s26, 1
s_cbranch_scc1 K_77
s_lshr_b32 s65, s60, 2
s_lshl_b32 s64, s24, 9
s_add_u32 s65, s65, s64
s_add_u32 s65, s65, 73400320
buffer_store_dwordx2 v[44:45], v24, s[4:7], s65 offen sc1
K_77:
v_mov_b64 v[54:55], 0
v_mov_b64 v[56:57], 0
v_mov_b64 v[58:59], 0
v_mov_b64 v[60:61], 0
v_mov_b64 v[62:63], 0
v_mov_b64 v[64:65], 0
v_mov_b64 v[66:67], 0
v_mov_b64 v[36:37], 0
v_mov_b64 v[38:39], 0
v_pk_mul_f32 v[16:17], v[16:17], v[68:69] op_sel_hi:[1,0]
v_pk_mul_f32 v[18:19], v[18:19], v[68:69] op_sel_hi:[1,0]
v_pk_mul_f32 v[20:21], v[20:21], v[68:69] op_sel_hi:[1,0]
v_pk_mul_f32 v[22:23], v[22:23], v[68:69] op_sel_hi:[1,0]
v_cvt_pk_bf16_f32 v40, v16, v17
v_cvt_pk_bf16_f32 v41, v18, v19
v_cvt_pk_bf16_f32 v42, v20, v21
v_cvt_pk_bf16_f32 v43, v22, v23
s_mov_b32 exec_lo, 0x33333333
s_mov_b32 exec_hi, 0x33333333
ds_write_b64 v4, v[40:41]
ds_write_b64 v4, v[42:43] offset:1024
s_mov_b64 exec, -1
s_cmp_eq_u32 s50, 63
s_cbranch_scc1 RECEND
s_waitcnt lgkmcnt(0)
s_barrier
ds_read_b128 v[44:47], v5 offset:18432
ds_read_b128 v[48:51], v5 offset:19456
v_mov_b32 v25, -2
v_lshrrev_b32 v68, 7, v0
v_mul_u32_u24 v68, 10240, v68
v_and_b32 v69, 0x70, v0
v_add_u32 v68, v68, v69
v_bfe_u32 v69, v0, 6, 1
v_lshlrev_b32 v69, 5, v69
v_lshrrev_b32 v70, 9, v0
v_lshl_add_u32 v69, v70, 4, v69
v_bfe_u32 v70, v0, 4, 2
v_lshl_add_u32 v69, v70, 2, v69
s_lshl_b32 s28, s24, 6
s_add_u32 s29, s28, 145408
v_add_u32 v70, s29, v69
s_add_u32 s37, s52, s59
s_add_u32 s36, s37, 10240
s_add_u32 s37, s37, s28
s_waitcnt lgkmcnt(1)
v_smfmac_f32_16x16x64_bf16 v[52:55], v[44:47], v[176:183], v1
s_waitcnt lgkmcnt(0)
v_smfmac_f32_16x16x64_bf16 v[52:55], v[48:51], v[216:223], v1
v_smfmac_f32_16x16x64_bf16 v[56:59], v[44:47], v[184:191], v1
v_smfmac_f32_16x16x64_bf16 v[56:59], v[48:51], v[224:231], v1
v_smfmac_f32_16x16x64_bf16 v[60:63], v[44:47], v[192:199], v1
v_pk_add_f32 v[52:53], v[52:53], v[54:55]
v_and_or_b32 v52, v52, v25, s54
buffer_store_dwordx2 v[52:53], v24, s[4:7], s55 offen offset:0
v_smfmac_f32_16x16x64_bf16 v[60:63], v[48:51], v[232:239], v1
v_smfmac_f32_16x16x64_bf16 v[64:67], v[44:47], v[200:207], v1
v_pk_add_f32 v[56:57], v[56:57], v[58:59]
v_and_or_b32 v56, v56, v25, s54
buffer_store_dwordx2 v[56:57], v24, s[4:7], s55 offen offset:2048
v_smfmac_f32_16x16x64_bf16 v[64:67], v[48:51], v[240:247], v1
v_smfmac_f32_16x16x64_bf16 v[36:39], v[44:47], v[208:215], v1
v_pk_add_f32 v[60:61], v[60:61], v[62:63]
v_and_or_b32 v60, v60, v25, s54
buffer_store_dwordx2 v[60:61], v24, s[4:7], s56 offen offset:0
v_smfmac_f32_16x16x64_bf16 v[36:39], v[48:51], v[248:255], v1
v_pk_add_f32 v[64:65], v[64:65], v[66:67]
v_and_or_b32 v64, v64, v25, s54
buffer_store_dwordx2 v[64:65], v24, s[4:7], s56 offen offset:2048
s_nop 4
v_pk_add_f32 v[36:37], v[36:37], v[38:39]
v_and_or_b32 v36, v36, v25, s54
buffer_store_dwordx2 v[36:37], v24, s[4:7], s57 offen offset:0
s_cmp_ge_u32 s25, 20
s_cbranch_scc1 NR_78
buffer_load_dwordx4 v[52:55], v68, s[4:7], s58 offen sc1
buffer_load_dwordx4 v[56:59], v68, s[4:7], s32 offen sc1
buffer_load_dwordx4 v[60:63], v68, s[4:7], s33 offen sc1
buffer_load_dwordx4 v[64:67], v68, s[4:7], s34 offen sc1
NR_78:
s_add_u32 s60, s60, 262144
s_and_b32 s64, s50, 3
s_cmp_lg_u32 s64, 2
s_cbranch_scc1 C_80
s_cmp_ge_u32 s50, 60
s_cbranch_scc1 C_80
s_lshl_b32 s65, s24, 8
s_add_u32 s65, s65, 160768
v_lshrrev_b32 v26, 2, v0
v_add_u32 v26, s65, v26
ds_read_b32 v26, v26
s_waitcnt lgkmcnt(0)
v_cmp_eq_u32 vcc, 0, v26
s_cbranch_vccz C_80
s_lshr_b32 s64, s50, 2
s_lshl_b32 s64, s64, 8
s_add_u32 s64, s64, 1280
v_mbcnt_lo_u32_b32 v27, -1, 0
v_mbcnt_hi_u32_b32 v27, -1, v27
v_lshlrev_b32 v27, 2, v27
s_mov_b32 s28, 0
PL_81:
buffer_load_dword v26, v27, s[4:7], s64 offen sc1
s_waitcnt vmcnt(0)
v_cmp_eq_u32 vcc, 0, v26
s_cbranch_vccz PD_82
s_add_u32 s28, s28, 1
s_cmp_lt_u32 s28, 131072
s_cbranch_scc1 PL_81
v_mov_b32 v2, 15
v_mov_b32 v3, 200864
buffer_store_dword v2, v3, s[4:7], 0 offen sc1
s_waitcnt vmcnt(0)
s_endpgm
PD_82:
C_80:
s_lshl_b32 s46, s50, 10
s_add_u32 s46, s46, s63
s_mov_b32 s64, s51
s_mov_b32 s51, s52
s_mov_b32 s52, s53
s_mov_b32 s53, s64
s_add_u32 s70, s51, s61
s_add_u32 s71, s51, s62
s_mov_b32 s35, s54
s_xor_b32 s54, s54, 1
s_add_u32 s50, s50, 1
v_mov_b64 v[28:29], 0
v_mov_b64 v[30:31], 0
v_mov_b64 v[32:33], 0
v_mov_b64 v[34:35], 0
v_mov_b64 v[36:37], 0
v_mov_b64 v[38:39], 0
s_cmp_ge_u32 s25, 20
s_cbranch_scc1 NR_79
NR_79:
v_mov_b64 v[40:41], 0
v_mov_b64 v[42:43], 0
v_mov_b64 v[44:45], 0
v_mov_b64 v[46:47], 0
v_mov_b64 v[48:49], 0
v_mov_b64 v[50:51], 0
s_cbranch_scc1 STEP_F
RP_83:
s_waitcnt vmcnt(0)
v_bitop3_b32 v24, v52, v54, s35 bitop3:0x7e
v_bitop3_b32 v25, v56, v58, s35 bitop3:0x7e
v_bitop3_b32 v26, v60, v62, s35 bitop3:0x7e
v_bitop3_b32 v27, v64, v66, s35 bitop3:0x7e
v_or3_b32 v24, v24, v25, v26
v_bitop3_b32 v24, v24, v27, 1 bitop3:0xa8
v_cmp_ne_u32 vcc, 0, v24
s_cbranch_vccz RD_84
buffer_load_dwordx4 v[52:55], v68, s[4:7], s58 offen sc1
buffer_load_dwordx4 v[56:59], v68, s[4:7], s32 offen sc1
buffer_load_dwordx4 v[60:63], v68, s[4:7], s33 offen sc1
buffer_load_dwordx4 v[64:67], v68, s[4:7], s34 offen sc1
s_add_u32 s67, s67, 1
s_cmp_lt_u32 s67, 131072
s_cbranch_scc1 RP_83
v_mov_b32 v2, 16
v_mov_b32 v3, 200864
buffer_store_dword v2, v3, s[4:7], 0 offen sc1
s_waitcnt vmcnt(0)
s_endpgm
RD_84:
v_pk_add_f32 v[52:53], v[52:53], v[56:57]
v_pk_add_f32 v[54:55], v[54:55], v[58:59]
v_pk_add_f32 v[60:61], v[60:61], v[64:65]
v_pk_add_f32 v[62:63], v[62:63], v[66:67]
v_pk_add_f32 v[24:25], v[52:53], v[60:61]
v_pk_add_f32 v[26:27], v[54:55], v[62:63]
RD_86:
s_nop 0
v_permlane32_swap_b32 v24, v25
v_permlane32_swap_b32 v26, v27
v_add_f32 v24, v24, v25
v_add_f32 v26, v26, v27
s_nop 1
v_permlane16_swap_b32 v24, v26
v_add_f32 v24, v24, v26
s_nop 1
v_add_f32_dpp v24, v24, v24 row_ror:8 row_mask:0xf bank_mask:0xf
v_mov_b32 v25, v24
s_nop 1
v_permlane16_swap_b32 v24, v25
v_cvt_pk_bf16_f32 v24, v24, v25
v_min_u32 v24, -2, v24
s_mov_b32 exec_lo, 0xff
s_mov_b32 exec_hi, 0xff
buffer_store_dword v24, v69, s[4:7], s37 offen
ds_write_b32 v70, v24
s_mov_b64 exec, -1
s_cmp_lg_u32 s24, 0
s_cbranch_scc1 STEP_F
v_lshrrev_b32 v26, 2, v0
v_add_u32 v71, 145408, v26
LS_87:
ds_read_b32 v25, v71
s_waitcnt lgkmcnt(0)
v_cmp_eq_u32 vcc, -1, v25
s_cbranch_vccz LS_88
s_add_u32 s67, s67, 1
s_cmp_lt_u32 s67, 131072
s_cbranch_scc1 LS_87
v_mov_b32 v2, 17
v_mov_b32 v3, 200864
buffer_store_dword v2, v3, s[4:7], 0 offen sc1
s_waitcnt vmcnt(0)
s_endpgm
LS_88:
buffer_store_dword v25, v26, s[4:7], s36 offen sc1
v_mov_b32 v27, -1
ds_write_b32 v71, v27
s_branch STEP_F
STEP_S:
s_cmp_eq_u32 s24, 0
s_cbranch_scc1 Z_89
buffer_load_dwordx4 v[8:11], v0, s[4:7], s70 offen offset:0 sc1
buffer_load_dwordx4 v[12:15], v0, s[4:7], s70 offen offset:1024 sc1
GP_91:
s_waitcnt vmcnt(0)
v_max3_u32 v68, v8, v9, v10
v_max3_u32 v68, v68, v11, v12
v_max3_u32 v69, v13, v14, v15
v_max_u32 v68, v68, v69
v_cmp_eq_u32 vcc, -1, v68
s_cbranch_vccz GD_92
buffer_load_dwordx4 v[8:11], v0, s[4:7], s70 offen offset:0 sc1
buffer_load_dwordx4 v[12:15], v0, s[4:7], s70 offen offset:1024 sc1
s_add_u32 s67, s67, 1
s_cmp_lt_u32 s67, 131072
s_cbranch_scc1 GP_91
v_mov_b32 v2, 11
v_mov_b32 v3, 200864
buffer_store_dword v2, v3, s[4:7], 0 offen sc1
s_waitcnt vmcnt(0)
s_endpgm
GD_92:
v_add_u32 v68, s48, v0
ds_write_b128 v68, v[8:11]
ds_write_b128 v68, v[12:15] offset:1024
s_branch LD_90
Z_89:
s_waitcnt vmcnt(1)
LD_90:
s_waitcnt lgkmcnt(0)
s_barrier
ds_read_b128 v[8:11], v5 offset:0
ds_read_b128 v[52:55], v6 offset:0
ds_read_b128 v[56:59], v6 offset:1024
ds_read_b128 v[12:15], v5 offset:1024
ds_read_b128 v[16:19], v5 offset:2048
ds_read_b128 v[20:23], v5 offset:3072
ds_read_b128 v[24:27], v5 offset:4096
s_cmp_eq_u32 s24, 0
s_cbranch_scc1 W_93
buffer_load_dwordx4 v[60:63], v0, s[4:7], s71 offen offset:0 sc1
buffer_load_dwordx4 v[64:67], v0, s[4:7], s71 offen offset:1024 sc1
W_93:
s_waitcnt lgkmcnt(6)
v_smfmac_f32_16x16x64_bf16 v[28:31], v[8:11], a[0:7], v1
v_smfmac_f32_16x16x64_bf16 v[36:39], v[8:11], a[8:15], v1
v_smfmac_f32_16x16x64_bf16 v[32:35], v[8:11], a[16:23], v1
v_smfmac_f32_16x16x64_bf16 v[40:43], v[8:11], a[24:31], v1
v_smfmac_f32_16x16x64_bf16 v[44:47], v[8:11], a[32:39], v1
s_waitcnt lgkmcnt(4)
v_smfmac_f32_16x16x64_bf16 v[48:51], v[8:11], v[52:59], v1
ds_read_b128 v[52:55], v6 offset:8192
ds_read_b128 v[56:59], v6 offset:9216
s_lshl_b32 s65, s24, 11
s_add_u32 s64, s60, s65
s_add_u32 s64, s64, 4194304
s_add_u32 m0, s65, 151552
s_lshl_b32 s66, s24, 10
buffer_load_dwordx4 v0, s[4:7], s64 offen sc1 lds
buffer_load_dwordx4 v0, s[4:7], s64 offen offset:1024 sc1 lds
s_waitcnt lgkmcnt(5)
v_smfmac_f32_16x16x64_bf16 v[28:31], v[12:15], a[40:47], v1
v_smfmac_f32_16x16x64_bf16 v[36:39], v[12:15], a[48:55], v1
v_smfmac_f32_16x16x64_bf16 v[32:35], v[12:15], a[56:63], v1
v_smfmac_f32_16x16x64_bf16 v[40:43], v[12:15], a[64:71], v1
v_smfmac_f32_16x16x64_bf16 v[44:47], v[12:15], a[72:79], v1
s_waitcnt lgkmcnt(0)
v_smfmac_f32_16x16x64_bf16 v[48:51], v[12:15], v[52:59], v1
ds_read_b128 v[52:55], v6 offset:16384
ds_read_b128 v[56:59], v6 offset:17408
s_add_u32 s64, s60, s66
s_add_u32 s64, s64, 20971520
s_add_u32 m0, s65, 122880
s_add_u32 s66, s64, 3072
buffer_load_dwordx4 v0, s[4:7], s64 offen sc1 lds
buffer_load_dwordx4 v0, s[4:7], s66 offen offset:1024 sc1 lds
v_smfmac_f32_16x16x64_bf16 v[28:31], v[16:19], a[80:87], v1
v_smfmac_f32_16x16x64_bf16 v[36:39], v[16:19], a[88:95], v1
v_smfmac_f32_16x16x64_bf16 v[32:35], v[16:19], a[96:103], v1
v_smfmac_f32_16x16x64_bf16 v[40:43], v[16:19], a[104:111], v1
v_smfmac_f32_16x16x64_bf16 v[44:47], v[16:19], a[112:119], v1
s_waitcnt lgkmcnt(0)
v_smfmac_f32_16x16x64_bf16 v[48:51], v[16:19], v[52:59], v1
ds_read_b128 v[52:55], v6 offset:24576
ds_read_b128 v[56:59], v6 offset:25600
v_smfmac_f32_16x16x64_bf16 v[28:31], v[20:23], a[120:127], v1
v_smfmac_f32_16x16x64_bf16 v[36:39], v[20:23], a[128:135], v1
v_smfmac_f32_16x16x64_bf16 v[32:35], v[20:23], a[136:143], v1
v_smfmac_f32_16x16x64_bf16 v[40:43], v[20:23], a[144:151], v1
v_smfmac_f32_16x16x64_bf16 v[44:47], v[20:23], a[152:159], v1
s_waitcnt lgkmcnt(0)
v_smfmac_f32_16x16x64_bf16 v[48:51], v[20:23], v[52:59], v1
ds_read_b128 v[52:55], v6 offset:32768
ds_read_b128 v[56:59], v6 offset:33792
v_smfmac_f32_16x16x64_bf16 v[28:31], v[24:27], a[160:167], v1
v_smfmac_f32_16x16x64_bf16 v[36:39], v[24:27], a[168:175], v1
v_smfmac_f32_16x16x64_bf16 v[32:35], v[24:27], a[176:183], v1
v_smfmac_f32_16x16x64_bf16 v[40:43], v[24:27], a[184:191], v1
v_smfmac_f32_16x16x64_bf16 v[44:47], v[24:27], a[192:199], v1
s_waitcnt lgkmcnt(0)
v_smfmac_f32_16x16x64_bf16 v[48:51], v[24:27], v[52:59], v1
s_cmp_eq_u32 s24, 0
s_cbranch_scc1 W_94
GP_96:
s_waitcnt vmcnt(0)
v_max3_u32 v68, v60, v61, v62
v_max3_u32 v68, v68, v63, v64
v_max3_u32 v69, v65, v66, v67
v_max_u32 v68, v68, v69
v_cmp_eq_u32 vcc, -1, v68
s_cbranch_vccz GD_97
buffer_load_dwordx4 v[60:63], v0, s[4:7], s71 offen offset:0 sc1
buffer_load_dwordx4 v[64:67], v0, s[4:7], s71 offen offset:1024 sc1
s_add_u32 s67, s67, 1
s_cmp_lt_u32 s67, 131072
s_cbranch_scc1 GP_96
v_mov_b32 v2, 13
v_mov_b32 v3, 200864
buffer_store_dword v2, v3, s[4:7], 0 offen sc1
s_waitcnt vmcnt(0)
s_endpgm
GD_97:
v_add_u32 v68, s49, v0
ds_write_b128 v68, v[60:63]
ds_write_b128 v68, v[64:67] offset:1024
s_branch W_95
W_94:
s_waitcnt vmcnt(0)
W_95:
s_waitcnt lgkmcnt(0)
s_barrier
ds_read_b128 v[8:11], v5 offset:5120
ds_read_b128 v[12:15], v5 offset:6144
ds_read_b128 v[16:19], v5 offset:7168
ds_read_b128 v[20:23], v5 offset:8192
ds_read_b128 v[24:27], v5 offset:9216
ds_read_b128 v[52:55], v5 offset:20480
ds_read_b128 v[56:59], v5 offset:21504
ds_read_b128 v[60:63], v5 offset:22528
ds_read_b128 v[64:67], v5 offset:23552
buffer_store_dword v1, off, s[4:7], s46 sc1
s_waitcnt lgkmcnt(8)
v_smfmac_f32_16x16x64_bf16 v[28:31], v[8:11], a[200:207], v1
s_waitcnt lgkmcnt(7)
v_smfmac_f32_16x16x64_bf16 v[28:31], v[12:15], a[232:239], v1
s_waitcnt lgkmcnt(6)
v_smfmac_f32_16x16x64_bf16 v[28:31], v[16:19], v[80:87], v1
s_waitcnt lgkmcnt(5)
v_smfmac_f32_16x16x64_bf16 v[28:31], v[20:23], v[112:119], v1
s_waitcnt lgkmcnt(4)
v_smfmac_f32_16x16x64_bf16 v[28:31], v[24:27], v[144:151], v1
v_lshlrev_b32 v70, 2, v0
s_add_u32 s64, s60, s47
s_mov_b32 m0, 159744
v_smfmac_f32_16x16x64_bf16 v[32:35], v[8:11], a[216:223], v1
buffer_load_dword v70, s[4:7], s64 offen sc1 lds
v_smfmac_f32_16x16x64_bf16 v[32:35], v[12:15], a[248:255], v1
v_smfmac_f32_16x16x64_bf16 v[32:35], v[16:19], v[96:103], v1
v_smfmac_f32_16x16x64_bf16 v[32:35], v[20:23], v[128:135], v1
v_smfmac_f32_16x16x64_bf16 v[32:35], v[24:27], v[160:167], v1
v_pk_add_f32 v[28:29], v[28:29], v[30:31]
v_cvt_pk_bf16_f32 v68, v28, v29
v_smfmac_f32_16x16x64_bf16 v[36:39], v[8:11], a[208:215], v1
s_and_b32 s64, s50, 3
s_cmp_lg_u32 s64, 1
s_cbranch_scc1 B_98
s_lshr_b32 s64, s50, 2
s_lshl_b32 s64, s64, 8
s_add_u32 s64, s64, 1280
s_lshl_b32 s65, s24, 8
s_add_u32 m0, s65, 160768
v_lshrrev_b32 v71, 2, v0
buffer_load_dword v71, s[4:7], s64 offen sc1 lds
B_98:
v_smfmac_f32_16x16x64_bf16 v[36:39], v[12:15], a[240:247], v1
v_smfmac_f32_16x16x64_bf16 v[36:39], v[16:19], v[88:95], v1
v_pk_add_f32 v[32:33], v[32:33], v[34:35]
v_cvt_pk_bf16_f32 v69, v32, v33
ds_write_b64 v2, v[68:69]
v_smfmac_f32_16x16x64_bf16 v[36:39], v[20:23], v[120:127], v1
v_smfmac_f32_16x16x64_bf16 v[36:39], v[24:27], v[152:159], v1
v_smfmac_f32_16x16x64_bf16 v[40:43], v[8:11], a[224:231], v1
s_cmp_lg_u32 s24, 0
s_cbranch_scc1 B_99
s_cmp_ge_u32 s25, 20
s_cbranch_scc1 B_99
v_mov_b32 v70, -1
v_lshrrev_b32 v71, 2, v0
s_add_u32 s64, s53, s59
s_add_u32 s65, s64, 10240
buffer_store_dword v70, v71, s[4:7], s64 offen sc1
buffer_store_dword v70, v71, s[4:7], s65 offen sc1
B_99:
v_smfmac_f32_16x16x64_bf16 v[40:43], v[12:15], v[72:79], v1
v_smfmac_f32_16x16x64_bf16 v[40:43], v[16:19], v[104:111], v1
v_pk_add_f32 v[36:37], v[36:37], v[38:39]
v_cvt_pk_bf16_f32 v70, v36, v37
v_smfmac_f32_16x16x64_bf16 v[40:43], v[20:23], v[136:143], v1
v_smfmac_f32_16x16x64_bf16 v[40:43], v[24:27], v[168:175], v1
s_lshr_b32 s45, s60, 1
s_lshl_b32 s64, s24, 10
s_add_u32 s45, s45, s64
s_add_u32 s45, s45, 65011712
s_nop 3
v_pk_add_f32 v[40:41], v[40:41], v[42:43]
v_cvt_pk_bf16_f32 v71, v40, v41
ds_write_b64 v2, v[70:71] offset:2048
s_waitcnt lgkmcnt(0)
s_barrier
ds_read_b64_tr_b16 v[8:9], v3 offset:0
ds_read_b64_tr_b16 v[10:11], v3 offset:128
ds_read_b64_tr_b16 v[12:13], v3 offset:1024
ds_read_b64_tr_b16 v[14:15], v3 offset:1152
ds_read_b64_tr_b16 v[16:17], v3 offset:2048
ds_read_b64_tr_b16 v[18:19], v3 offset:2176
ds_read_b64_tr_b16 v[20:21], v3 offset:3072
ds_read_b64_tr_b16 v[22:23], v3 offset:3200
s_cmp_lg_u32 s26, 0
s_cbranch_scc1 K_100
buffer_store_dwordx4 v[68:71], v0, s[4:7], s45 offen sc1
K_100:
ds_read_b128 v[24:27], v5 offset:24576
ds_read_b128 v[40:43], v5 offset:25600
ds_read_b128 v[36:39], v5 offset:26624
s_waitcnt lgkmcnt(9)
s_nop 1
v_mfma_f32_16x16x32_bf16 v[28:31], v[52:55], v[8:11], 0
v_mfma_f32_16x16x32_bf16 v[32:35], v[56:59], v[8:11], 0
v_mfma_f32_16x16x32_bf16 v[68:71], v[8:11], v[8:11], 0
ds_read_b128 v[52:55], v5 offset:27648
ds_read_b128 v[8:11], v5 offset:5120
s_waitcnt lgkmcnt(9)
v_mfma_f32_16x16x32_bf16 v[28:31], v[60:63], v[12:15], v[28:31]
v_mfma_f32_16x16x32_bf16 v[32:35], v[64:67], v[12:15], v[32:35]
v_mfma_f32_16x16x32_bf16 v[68:71], v[12:15], v[12:15], v[68:71]
ds_read_b128 v[60:63], v6 offset:40960
ds_read_b128 v[64:67], v6 offset:41984
ds_read_b128 v[12:15], v5 offset:6144
s_waitcnt lgkmcnt(6)
v_mfma_f32_16x16x32_bf16 v[28:31], v[24:27], v[16:19], v[28:31]
v_mfma_f32_16x16x32_bf16 v[32:35], v[40:43], v[16:19], v[32:35]
v_mfma_f32_16x16x32_bf16 v[68:71], v[16:19], v[16:19], v[68:71]
ds_read_b128 v[16:19], v5 offset:7168
ds_read_b128 v[24:27], v5 offset:9216
s_waitcnt lgkmcnt(6)
v_mfma_f32_16x16x32_bf16 v[28:31], v[36:39], v[20:23], v[28:31]
v_mfma_f32_16x16x32_bf16 v[32:35], v[52:55], v[20:23], v[32:35]
v_mfma_f32_16x16x32_bf16 v[68:71], v[20:23], v[20:23], v[68:71]
ds_read_b128 v[20:23], v5 offset:8192
ds_read_b128 v[36:39], v6 offset:49152
ds_read_b128 v[40:43], v6 offset:50176
ds_read_b128 v[52:55], v6 offset:57344
ds_read_b128 v[56:59], v6 offset:58368
s_waitcnt lgkmcnt(10)
s_waitcnt lgkmcnt(8)
v_smfmac_f32_16x16x64_bf16 v[44:47], v[8:11], v[60:67], v1
ds_read_b128 v[60:63], v7 offset:0
ds_read_b128 v[64:67], v7 offset:1024
v_max3_f32 v68, v28, v29, v30
v_max3_f32 v69, v31, v32, v33
v_max3_f32 v68, v68, v34, v35
v_max3_f32 v69, v69, v70, v71
v_max_f32 v68, v68, v69
v_mov_b32 v69, v68
s_waitcnt lgkmcnt(4)
v_smfmac_f32_16x16x64_bf16 v[48:51], v[8:11], v[36:43], v1
ds_read_b128 v[36:39], v7 offset:8192
ds_read_b128 v[40:43], v7 offset:9216
ds_read_b128 v[8:11], v7 offset:57344
v_permlane16_swap_b32 v68, v69
v_max_f32 v68, v68, v69
v_mov_b32 v69, v68
s_waitcnt lgkmcnt(5)
v_smfmac_f32_16x16x64_bf16 v[44:47], v[12:15], v[52:59], v1
ds_read_b128 v[52:55], v7 offset:16384
ds_read_b128 v[56:59], v7 offset:17408
v_permlane32_swap_b32 v68, v69
v_max_f32 v68, v68, v69
v_mul_f32 v68, s68, v68
v_pk_fma_f32 v[28:29], v[28:29], s[68:69], v[68:69] op_sel_hi:[1,0,0] neg_lo:[0,0,1] neg_hi:[0,0,1]
v_pk_fma_f32 v[30:31], v[30:31], s[68:69], v[68:69] op_sel_hi:[1,0,0] neg_lo:[0,0,1] neg_hi:[0,0,1]
v_pk_fma_f32 v[32:33], v[32:33], s[68:69], v[68:69] op_sel_hi:[1,0,0] neg_lo:[0,0,1] neg_hi:[0,0,1]
v_pk_fma_f32 v[34:35], v[34:35], s[68:69], v[68:69] op_sel_hi:[1,0,0] neg_lo:[0,0,1] neg_hi:[0,0,1]
v_pk_fma_f32 v[70:71], v[70:71], s[68:69], v[68:69] op_sel_hi:[1,0,0] neg_lo:[0,0,1] neg_hi:[0,0,1]
s_waitcnt lgkmcnt(5)
v_smfmac_f32_16x16x64_bf16 v[48:51], v[12:15], v[60:67], v1
ds_read_b128 v[60:63], v7 offset:24576
ds_read_b128 v[64:67], v7 offset:25600
ds_read_b128 v[12:15], v7 offset:58368
v_exp_f32 v28, v28
v_exp_f32 v29, v29
v_exp_f32 v30, v30
s_waitcnt lgkmcnt(6)
v_smfmac_f32_16x16x64_bf16 v[44:47], v[16:19], v[36:43], v1
ds_read_b128 v[36:39], v7 offset:32768
ds_read_b128 v[40:43], v7 offset:33792
v_exp_f32 v31, v31
v_exp_f32 v32, v32
s_waitcnt lgkmcnt(5)
v_smfmac_f32_16x16x64_bf16 v[48:51], v[16:19], v[52:59], v1
ds_read_b128 v[52:55], v7 offset:40960
ds_read_b128 v[56:59], v7 offset:41984
v_exp_f32 v33, v33
v_exp_f32 v34, v34
s_waitcnt lgkmcnt(5)
v_smfmac_f32_16x16x64_bf16 v[44:47], v[20:23], v[60:67], v1
ds_read_b128 v[60:63], v7 offset:49152
ds_read_b128 v[64:67], v7 offset:50176
v_exp_f32 v35, v35
v_exp_f32 v70, v70
s_waitcnt lgkmcnt(4)
v_smfmac_f32_16x16x64_bf16 v[48:51], v[20:23], v[36:43], v1
v_exp_f32 v71, v71
v_pk_add_f32 v[68:69], v[28:29], v[30:31]
v_pk_add_f32 v[68:69], v[68:69], v[32:33]
s_waitcnt lgkmcnt(2)
v_smfmac_f32_16x16x64_bf16 v[44:47], v[24:27], v[52:59], v1
v_pk_add_f32 v[68:69], v[68:69], v[34:35]
v_pk_add_f32 v[68:69], v[68:69], v[70:71]
v_cvt_pk_bf16_f32 v28, v28, v29
v_cvt_pk_bf16_f32 v29, v30, v31
s_waitcnt lgkmcnt(0)
v_smfmac_f32_16x16x64_bf16 v[48:51], v[24:27], v[60:67], v1
v_cvt_pk_bf16_f32 v30, v32, v33
v_cvt_pk_bf16_f32 v31, v34, v35
v_cvt_pk_bf16_f32 v32, v70, v71
v_mov_b64 v[34:35], 0
v_add_f32 v68, v68, v69
v_mfma_f32_16x16x32_bf16 v[16:19], v[8:11], v[28:31], 0
v_mfma_f32_16x16x32_bf16 v[20:23], v[12:15], v[28:31], 0
v_mov_b32 v33, 0
v_mov_b32 v35, v32
v_mov_b32 v69, v68
v_lshrrev_b32 v24, 1, v0
s_nop 0
v_permlane16_swap_b32 v68, v69
v_pk_add_f32 v[44:45], v[44:45], v[46:47]
v_pk_add_f32 v[48:49], v[48:49], v[50:51]
v_add_f32 v68, v68, v69
v_cvt_pk_bf16_f32 v44, v44, v45
v_cvt_pk_bf16_f32 v45, v48, v49
v_mov_b32 v69, v68
v_mov_b64 v[52:53], 0
v_mfma_f32_16x16x16_bf16 v[16:19], v[44:45], v[32:33], v[16:19]
v_mfma_f32_16x16x16_bf16 v[20:23], v[44:45], v[34:35], v[20:23]
v_permlane32_swap_b32 v68, v69
v_add_f32 v68, v68, v69
v_rcp_f32 v68, v68
s_cmp_lg_u32 s26, 1
s_cbranch_scc1 K_101
s_lshr_b32 s65, s60, 2
s_lshl_b32 s64, s24, 9
s_add_u32 s65, s65, s64
s_add_u32 s65, s65, 73400320
buffer_store_dwordx2 v[44:45], v24, s[4:7], s65 offen sc1
K_101:
v_mov_b64 v[54:55], 0
v_mov_b64 v[56:57], 0
v_mov_b64 v[58:59], 0
v_mov_b64 v[60:61], 0
v_mov_b64 v[62:63], 0
v_mov_b64 v[64:65], 0
v_mov_b64 v[66:67], 0
v_mov_b64 v[36:37], 0
v_mov_b64 v[38:39], 0
v_pk_mul_f32 v[16:17], v[16:17], v[68:69] op_sel_hi:[1,0]
v_pk_mul_f32 v[18:19], v[18:19], v[68:69] op_sel_hi:[1,0]
v_pk_mul_f32 v[20:21], v[20:21], v[68:69] op_sel_hi:[1,0]
v_pk_mul_f32 v[22:23], v[22:23], v[68:69] op_sel_hi:[1,0]
v_cvt_pk_bf16_f32 v40, v16, v17
v_cvt_pk_bf16_f32 v41, v18, v19
v_cvt_pk_bf16_f32 v42, v20, v21
v_cvt_pk_bf16_f32 v43, v22, v23
s_mov_b32 exec_lo, 0x33333333
s_mov_b32 exec_hi, 0x33333333
ds_write_b64 v4, v[40:41]
ds_write_b64 v4, v[42:43] offset:1024
s_mov_b64 exec, -1
s_cmp_eq_u32 s50, 63
s_cbranch_scc1 RECEND
s_waitcnt lgkmcnt(0)
s_barrier
ds_read_b128 v[44:47], v5 offset:18432
ds_read_b128 v[48:51], v5 offset:19456
v_mov_b32 v25, -2
v_lshrrev_b32 v68, 7, v0
v_mul_u32_u24 v68, 10240, v68
v_and_b32 v69, 0x70, v0
v_add_u32 v68, v68, v69
v_bfe_u32 v69, v0, 6, 1
v_lshlrev_b32 v69, 5, v69
v_lshrrev_b32 v70, 9, v0
v_lshl_add_u32 v69, v70, 4, v69
v_bfe_u32 v70, v0, 4, 2
v_lshl_add_u32 v69, v70, 2, v69
s_lshl_b32 s28, s24, 6
s_add_u32 s29, s28, 145408
v_add_u32 v70, s29, v69
s_add_u32 s37, s52, s59
s_add_u32 s36, s37, 10240
s_add_u32 s37, s37, s28
s_waitcnt lgkmcnt(1)
v_smfmac_f32_16x16x64_bf16 v[52:55], v[44:47], v[176:183], v1
s_waitcnt lgkmcnt(0)
v_smfmac_f32_16x16x64_bf16 v[52:55], v[48:51], v[216:223], v1
v_smfmac_f32_16x16x64_bf16 v[56:59], v[44:47], v[184:191], v1
v_smfmac_f32_16x16x64_bf16 v[56:59], v[48:51], v[224:231], v1
v_smfmac_f32_16x16x64_bf16 v[60:63], v[44:47], v[192:199], v1
v_pk_add_f32 v[52:53], v[52:53], v[54:55]
v_and_or_b32 v52, v52, v25, s54
buffer_store_dwordx2 v[52:53], v24, s[4:7], s55 offen offset:0 sc1
v_smfmac_f32_16x16x64_bf16 v[60:63], v[48:51], v[232:239], v1
v_smfmac_f32_16x16x64_bf16 v[64:67], v[44:47], v[200:207], v1
v_pk_add_f32 v[56:57], v[56:57], v[58:59]
v_and_or_b32 v56, v56, v25, s54
buffer_store_dwordx2 v[56:57], v24, s[4:7], s55 offen offset:2048 sc1
v_smfmac_f32_16x16x64_bf16 v[64:67], v[48:51], v[240:247], v1
v_smfmac_f32_16x16x64_bf16 v[36:39], v[44:47], v[208:215], v1
v_pk_add_f32 v[60:61], v[60:61], v[62:63]
v_and_or_b32 v60, v60, v25, s54
buffer_store_dwordx2 v[60:61], v24, s[4:7], s56 offen offset:0 sc1
v_smfmac_f32_16x16x64_bf16 v[36:39], v[48:51], v[248:255], v1
v_pk_add_f32 v[64:65], v[64:65], v[66:67]
v_and_or_b32 v64, v64, v25, s54
buffer_store_dwordx2 v[64:65], v24, s[4:7], s56 offen offset:2048 sc1
s_nop 4
v_pk_add_f32 v[36:37], v[36:37], v[38:39]
v_and_or_b32 v36, v36, v25, s54
buffer_store_dwordx2 v[36:37], v24, s[4:7], s57 offen offset:0 sc1
s_cmp_ge_u32 s25, 20
s_cbranch_scc1 NR_102
buffer_load_dwordx4 v[52:55], v68, s[4:7], s58 offen sc1
buffer_load_dwordx4 v[56:59], v68, s[4:7], s32 offen sc1
buffer_load_dwordx4 v[60:63], v68, s[4:7], s33 offen sc1
buffer_load_dwordx4 v[64:67], v68, s[4:7], s34 offen sc1
NR_102:
s_add_u32 s60, s60, 262144
s_and_b32 s64, s50, 3
s_cmp_lg_u32 s64, 2
s_cbranch_scc1 C_104
s_cmp_ge_u32 s50, 60
s_cbranch_scc1 C_104
s_lshl_b32 s65, s24, 8
s_add_u32 s65, s65, 160768
v_lshrrev_b32 v26, 2, v0
v_add_u32 v26, s65, v26
ds_read_b32 v26, v26
s_waitcnt lgkmcnt(0)
v_cmp_eq_u32 vcc, 0, v26
s_cbranch_vccz C_104
s_lshr_b32 s64, s50, 2
s_lshl_b32 s64, s64, 8
s_add_u32 s64, s64, 1280
v_mbcnt_lo_u32_b32 v27, -1, 0
v_mbcnt_hi_u32_b32 v27, -1, v27
v_lshlrev_b32 v27, 2, v27
s_mov_b32 s28, 0
PL_105:
buffer_load_dword v26, v27, s[4:7], s64 offen sc1
s_waitcnt vmcnt(0)
v_cmp_eq_u32 vcc, 0, v26
s_cbranch_vccz PD_106
s_add_u32 s28, s28, 1
s_cmp_lt_u32 s28, 131072
s_cbranch_scc1 PL_105
v_mov_b32 v2, 15
v_mov_b32 v3, 200864
buffer_store_dword v2, v3, s[4:7], 0 offen sc1
s_waitcnt vmcnt(0)
s_endpgm
PD_106:
C_104:
s_lshl_b32 s46, s50, 10
s_add_u32 s46, s46, s63
s_mov_b32 s64, s51
s_mov_b32 s51, s52
s_mov_b32 s52, s53
s_mov_b32 s53, s64
s_add_u32 s70, s51, s61
s_add_u32 s71, s51, s62
s_mov_b32 s35, s54
s_xor_b32 s54, s54, 1
s_add_u32 s50, s50, 1
v_mov_b64 v[28:29], 0
v_mov_b64 v[30:31], 0
v_mov_b64 v[32:33], 0
v_mov_b64 v[34:35], 0
v_mov_b64 v[36:37], 0
v_mov_b64 v[38:39], 0
s_cmp_ge_u32 s25, 20
s_cbranch_scc1 NR_103
NR_103:
v_mov_b64 v[40:41], 0
v_mov_b64 v[42:43], 0
v_mov_b64 v[44:45], 0
v_mov_b64 v[46:47], 0
v_mov_b64 v[48:49], 0
v_mov_b64 v[50:51], 0
s_cbranch_scc1 STEP_S
RP_107:
s_waitcnt vmcnt(0)
v_bitop3_b32 v24, v52, v54, s35 bitop3:0x7e
v_bitop3_b32 v25, v56, v58, s35 bitop3:0x7e
v_bitop3_b32 v26, v60, v62, s35 bitop3:0x7e
v_bitop3_b32 v27, v64, v66, s35 bitop3:0x7e
v_or3_b32 v24, v24, v25, v26
v_bitop3_b32 v24, v24, v27, 1 bitop3:0xa8
v_cmp_ne_u32 vcc, 0, v24
s_cbranch_vccz RD_108
buffer_load_dwordx4 v[52:55], v68, s[4:7], s58 offen sc1
buffer_load_dwordx4 v[56:59], v68, s[4:7], s32 offen sc1
buffer_load_dwordx4 v[60:63], v68, s[4:7], s33 offen sc1
buffer_load_dwordx4 v[64:67], v68, s[4:7], s34 offen sc1
s_add_u32 s67, s67, 1
s_cmp_lt_u32 s67, 131072
s_cbranch_scc1 RP_107
v_mov_b32 v2, 16
v_mov_b32 v3, 200864
buffer_store_dword v2, v3, s[4:7], 0 offen sc1
s_waitcnt vmcnt(0)
s_endpgm
RD_108:
v_pk_add_f32 v[52:53], v[52:53], v[56:57]
v_pk_add_f32 v[54:55], v[54:55], v[58:59]
v_pk_add_f32 v[60:61], v[60:61], v[64:65]
v_pk_add_f32 v[62:63], v[62:63], v[66:67]
v_pk_add_f32 v[24:25], v[52:53], v[60:61]
v_pk_add_f32 v[26:27], v[54:55], v[62:63]
RD_110:
s_nop 0
v_permlane32_swap_b32 v24, v25
v_permlane32_swap_b32 v26, v27
v_add_f32 v24, v24, v25
v_add_f32 v26, v26, v27
s_nop 1
v_permlane16_swap_b32 v24, v26
v_add_f32 v24, v24, v26
s_nop 1
v_add_f32_dpp v24, v24, v24 row_ror:8 row_mask:0xf bank_mask:0xf
v_mov_b32 v25, v24
s_nop 1
v_permlane16_swap_b32 v24, v25
v_cvt_pk_bf16_f32 v24, v24, v25
v_min_u32 v24, -2, v24
s_mov_b32 exec_lo, 0xff
s_mov_b32 exec_hi, 0xff
buffer_store_dword v24, v69, s[4:7], s37 offen sc1
ds_write_b32 v70, v24
s_mov_b64 exec, -1
s_cmp_lg_u32 s24, 0
s_cbranch_scc1 STEP_S
v_lshrrev_b32 v26, 2, v0
v_add_u32 v71, 145408, v26
LS_111:
ds_read_b32 v25, v71
s_waitcnt lgkmcnt(0)
v_cmp_eq_u32 vcc, -1, v25
s_cbranch_vccz LS_112
s_add_u32 s67, s67, 1
s_cmp_lt_u32 s67, 131072
s_cbranch_scc1 LS_111
v_mov_b32 v2, 17
v_mov_b32 v3, 200864
buffer_store_dword v2, v3, s[4:7], 0 offen sc1
s_waitcnt vmcnt(0)
s_endpgm
LS_112:
buffer_store_dword v25, v26, s[4:7], s36 offen sc1
v_mov_b32 v27, -1
ds_write_b32 v71, v27
s_branch STEP_S
RECEND:
s_waitcnt vmcnt(0)
s_add_u32 s64, s63, 64512
buffer_store_dword v1, off, s[4:7], s64 sc1
s_waitcnt vmcnt(0)
s_endpgm
KEND:
s_endpgm
.section .rodata,"a"
.p2align 6
.amdhsa_kernel recurrent_scan__memory_aug_recurrent_mem_tr__swiglu_ffn__prompt_kernel
  .amdhsa_next_free_vgpr 512
  .amdhsa_next_free_sgpr 102
  .amdhsa_accum_offset 256
  .amdhsa_group_segment_fixed_size 0
  .amdhsa_kernarg_size 112
  .amdhsa_user_sgpr_count 2
  .amdhsa_user_sgpr_kernarg_segment_ptr 1
  .amdhsa_system_sgpr_workgroup_id_x 1
.end_amdhsa_kernel
```
